```python
import torch

def _softmax(x, axis=-1):
    return torch.softmax(x, dim=axis)
def _gelu(x):
    return torch.nn.functional.gelu(x, approximate="tanh")
def _silu(x):
    return torch.nn.functional.silu(x)
def _sigmoid(x):
    return torch.sigmoid(x)
def _layernorm(x, axis=-1, eps=1e-5):
    m = x.mean(dim=axis, keepdim=True)
    v = x.var(dim=axis, keepdim=True, unbiased=False)
    return (x - m) / torch.sqrt(v + eps)
def _scatter_add(tgt, idx, src, axis=0):
    return tgt.clone().index_add_(axis, idx, src)
def _segment_sum(src, seg, n):
    out = torch.zeros((n,) + src.shape[1:], dtype=src.dtype)
    return out.index_add_(0, seg, src)
def _pad(x, pw):
    flat = tuple(v for pair in reversed(pw) for v in pair)
    return torch.nn.functional.pad(x, flat)

kernel_name = 'gated_mix__sliding_block_cached__glu_gated_reglu__decode'

def setup_inputs():

    _w = (lambda a: (lambda t: t.to(torch.bfloat16) if t.is_floating_point() else t)(torch.as_tensor(a)))
    def _A_setup():
        B, Sq, D = 8, 1, 1024
        Hq, Hkv, Sk, Dh = 32, 4, 4096, 128
        assert Hq % Hkv == 0, (Hq, Hkv)
        return {
            "x": _w((lambda *s: torch.randn(*s, dtype=torch.bfloat16) * 0.05)(B, Sq, D)),
            "k_cache": _w((lambda *s: torch.randn(*s, dtype=torch.bfloat16) * 3.2)(B, Hkv, Sk, Dh)),
            "v_cache": _w((lambda *s: torch.randn(*s, dtype=torch.bfloat16) * 0.05)(B, Hkv, Sk, Dh)),
            "wq": _w((lambda *s: torch.randn(*s, dtype=torch.bfloat16) * 3.2)(D, Hq * Dh) * (D ** -0.5)),
            "wo": _w((lambda *s: torch.randn(*s, dtype=torch.bfloat16) * 0.05)(Hq * Dh, D) * ((Hq * Dh) ** -0.5)),
        }
    _A_in = _A_setup()

    def _B_setup():
        B, S, D, F = 8, 1, 1024, 3584
        return {
            "x": _w((lambda *s: torch.randn(*s, dtype=torch.bfloat16) * 0.05)(B, S, D)),
            "W_gate": _w((lambda *s: torch.randn(*s, dtype=torch.bfloat16) * 0.2)(D, F) * (2.0 / D) ** 0.5),
            "W_up": _w((lambda *s: torch.randn(*s, dtype=torch.bfloat16) * 0.2)(D, F) * (2.0 / D) ** 0.5),
            "W_down": _w((lambda *s: torch.randn(*s, dtype=torch.bfloat16) * 0.2)(F, D) * (1.0 / F) ** 0.5),
        }
    _B_in = _B_setup()

    return {
        "A_x": _A_in["x"],
        "A_k_cache": _A_in["k_cache"],
        "A_v_cache": _A_in["v_cache"],
        "A_wq": _A_in["wq"],
        "A_wo": _A_in["wo"],
        "B_x": _B_in["x"],
        "B_W_gate": _B_in["W_gate"],
        "B_W_up": _B_in["W_up"],
        "B_W_down": _B_in["W_down"],
        "gate_w": _w((lambda *s: torch.randn(*s, dtype=torch.bfloat16) * 0.05)(1024) * 16.0),
    }

def reference(A_x, A_k_cache, A_v_cache, A_wq, A_wo, B_x, B_W_gate, B_W_up, B_W_down, gate_w):
    def _A_ref(x, k_cache, v_cache, wq, wo):
        B, Sq, D = x.shape
        Hq, Dh = 32, 128
        Hkv, Sk = k_cache.shape[1], k_cache.shape[2]
        W = min(4096, max(256, Sk // 4))
        rep = Hq // Hkv
        q = (lambda x, *d: x.permute(*d))((x @ wq).reshape(B, Sq, Hq, Dh), 0, 2, 1, 3)
        k = (lambda x, n, axis: torch.repeat_interleave(x, n, dim=axis))(k_cache[:, :, Sk - W:, :], rep, axis=1)
        v = (lambda x, n, axis: torch.repeat_interleave(x, n, dim=axis))(v_cache[:, :, Sk - W:, :], rep, axis=1)
        scores = torch.einsum("bhqd,bhkd->bhqk", q, k) * (Dh ** -0.5)
        p = _softmax(scores, axis=-1)
        o = torch.einsum("bhqk,bhkd->bhqd", p, v)
        return (lambda x, *d: x.permute(*d))(o, 0, 2, 1, 3).reshape(B, Sq, Hq * Dh) @ wo

    def _B_ref(x, W_gate, W_up, W_down):
        gate = torch.einsum("bsd,df->bsf", x, W_gate)
        up = torch.einsum("bsd,df->bsf", x, W_up)
        gate = gate * (lambda x, dt: x.to(dt))(gate > 0, gate.dtype)
        h = gate * up
        return torch.einsum("bsf,fd->bsd", h, W_down)

    x = A_x
    g = _sigmoid((x * gate_w).sum(-1, keepdims=True))
    a = _A_ref(x, A_k_cache, A_v_cache, A_wq, A_wo)
    b = _B_ref(x, B_W_gate, B_W_up, B_W_down)
    return g * a + (1 - g) * b
```

```asm
; @launch grid=(256,1,1) block=(640,1,1) lds=155648
.amdgcn_target "amdgcn-amd-amdhsa--gfx950"
.text
.globl gated_mix__sliding_block_cached__glu_gated_reglu__decode_kernel
.p2align 8
.type gated_mix__sliding_block_cached__glu_gated_reglu__decode_kernel,@function
gated_mix__sliding_block_cached__glu_gated_reglu__decode_kernel:
L_start:
    s_load_dwordx16 s[16:31], s[0:1], 0
    s_load_dwordx8 s[32:39], s[0:1], 64
    s_load_dwordx2 s[40:41], s[0:1], 96
    s_getpc_b64 s[8:9]
L_pc:
    v_lshlrev_b32 v1, 7, v0
    v_min_u32 v1, L_last-L_pc, v1
    global_load_dword v63, v1, s[8:9]
    v_readfirstlane_b32 s3, v0
    s_cmpk_ge_u32 s2, 256
    s_cbranch_scc1 L_end
    s_mov_b32 s11, 0x20000
    s_cmpk_ge_u32 s3, 256
    s_cbranch_scc1 L_loader
    v_bfe_u32 v4, v0, 4, 2
    v_lshlrev_b32 v1, 1, v4
    v_xor_b32 v1, v1, v0
    v_and_b32 v1, 7, v1
    v_lshlrev_b32 v1, 4, v1
    v_lshl_add_u32 v1, v4, 13, v1
    v_and_b32 v2, 8, v0
    v_lshl_add_u32 v8, v2, 17, v1
    s_lshr_b32 s4, s2, 3
    s_and_b32 s4, s4, 28
    s_lshr_b32 s4, 0x37654210, s4
    s_and_b32 s4, s4, 7
    s_and_b32 s5, s2, 28
    s_lshl1_add_u32 s51, s5, s4
    s_and_b32 s5, s2, 3
    s_lshl_b32 s5, s5, 9
    s_add_u32 s12, s5, s3
    s_lshl_b32 s12, s12, 12
    s_lshl_b32 s4, s51, 7
    s_add_u32 s12, s12, s4
    s_lshl_b32 m0, s3, 7
    s_add_u32 s13, m0, 8192
    s_mov_b32 s10, 8388608
    s_waitcnt lgkmcnt(0)
    s_mov_b64 s[8:9], s[22:23]
L_q0:
    buffer_load_dwordx4 v8, s[8:11], s12 offen nt lds
    s_add_u32 m0, m0, 1024
    v_xor_b32 v8, 0x100000, v8
    s_add_u32 s12, s12, 32768
    s_cmp_lt_u32 m0, s13
    s_cbranch_scc1 L_q0
    v_and_b32 v1, 7, v0
    v_lshlrev_b32 v1, 11, v1
    v_lshrrev_b32 v2, 3, v0
    v_lshl_add_u32 v9, v2, 4, v1
    s_lshl_b32 s4, s3, 4
    s_add_u32 m0, s4, 131072
    s_mov_b64 s[8:9], s[16:17]
    s_movk_i32 s10, 0x4000
    buffer_load_dwordx4 v9, s[8:11], s5 offen lds
    s_barrier
    s_branch L_cons
L_loader:
    s_cmpk_ge_u32 s3, 320
    s_cbranch_scc0 L_ld0
    s_barrier
    s_branch L_helper
L_ld0:
    s_setprio 3
    v_and_b32 v0, 63, v0
    v_lshrrev_b32 v4, 4, v0
    v_and_b32 v3, 15, v0
    v_lshlrev_b32 v1, 1, v4
    v_xor_b32 v5, v3, v1
    v_lshlrev_b32 v5, 4, v5
    v_mov_b32 v14, 154112
    v_lshl_add_u32 v16, v0, 2, v14
    v_mov_b32 v17, 0
    ds_write_b32 v16, v17
    s_mov_b32 s46, 400000
    s_and_b32 s54, s2, 31
    s_lshr_b32 s55, s2, 5
    s_mov_b32 s7, -1
    s_mov_b32 m0, 32768
    s_cmpk_ge_u32 s2, 128
    s_cbranch_scc1 L_ld_notA
    v_xor_b32 v6, v3, v4
    v_lshlrev_b32 v6, 4, v6
    v_lshl_add_u32 v8, v4, 12, v6
    v_xor_b32 v9, 64, v8
    v_add_u32 v9, 15360, v9
    v_xor_b32 v10, 128, v8
    v_add_u32 v10, 30720, v10
    v_xor_b32 v11, 192, v8
    v_add_u32 v11, 46080, v11
    s_lshl_b32 s4, s54, 20
    s_lshl_b32 s5, s55, 16
    s_add_u32 s4, s4, s5
    s_add_u32 s15, s4, 786432
    s_add_u32 s7, s15, 4096
    s_lshl2_add_u32 s4, s55, s2
    s_and_b32 s4, s4, 15
    s_lshl_b32 s4, s4, 8
    s_add_u32 s12, s15, s4
    s_waitcnt lgkmcnt(0)
    s_mov_b64 s[8:9], s[18:19]
    s_mov_b32 s10, 33554432
    s_barrier
    s_mov_b32 s14, 256
    s_mov_b32 s13, 16
    s_call_b64 s[52:53], L_seg24
    s_branch L_ldA2
L_sel20_24:
    s_bitcmp1_b32 s2, 2
    s_cbranch_scc1 L_seg24
    s_branch L_seg20
L_seg24:
    buffer_load_dwordx4 v8, s[8:11], s12 offen offset:0 nt lds
    buffer_load_dwordx4 v9, s[8:11], s12 offen offset:1024 nt lds
    buffer_load_dwordx4 v10, s[8:11], s12 offen offset:2048 nt lds
    buffer_load_dwordx4 v11, s[8:11], s12 offen offset:3072 nt lds
    s_add_u32 m0, m0, 4096
    s_add_u32 s12, s12, s14
    s_cmp_eq_u32 s12, s7
    s_cselect_b32 s12, s15, s12
    v_add_u32 v17, 1, v17
    v_subrev_u32 v15, 6, v17
    s_waitcnt vmcnt(24)
    ds_write_b32 v14, v15
    s_sub_u32 s13, s13, 1
    s_cmp_lg_u32 s13, 0
    s_cbranch_scc1 L_seg24
    s_setpc_b64 s[52:53]
L_seg20:
    buffer_load_dwordx4 v8, s[8:11], s12 offen offset:0 nt lds
    buffer_load_dwordx4 v9, s[8:11], s12 offen offset:1024 nt lds
    buffer_load_dwordx4 v10, s[8:11], s12 offen offset:2048 nt lds
    buffer_load_dwordx4 v11, s[8:11], s12 offen offset:3072 nt lds
    s_add_u32 m0, m0, 4096
    s_add_u32 s12, s12, s14
    s_cmp_eq_u32 s12, s7
    s_cselect_b32 s12, s15, s12
    v_add_u32 v17, 1, v17
    v_subrev_u32 v15, 5, v17
    s_waitcnt vmcnt(20)
    ds_write_b32 v14, v15
    s_sub_u32 s13, s13, 1
    s_cmp_lg_u32 s13, 0
    s_cbranch_scc1 L_seg20
    s_setpc_b64 s[52:53]
L_seg28:
    buffer_load_dwordx4 v8, s[8:11], s12 offen offset:0 nt lds
    buffer_load_dwordx4 v9, s[8:11], s12 offen offset:1024 nt lds
    buffer_load_dwordx4 v10, s[8:11], s12 offen offset:2048 nt lds
    buffer_load_dwordx4 v11, s[8:11], s12 offen offset:3072 nt lds
    s_add_u32 m0, m0, 4096
    s_add_u32 s12, s12, s14
    s_cmp_eq_u32 s12, s7
    s_cselect_b32 s12, s15, s12
    v_add_u32 v17, 1, v17
    v_subrev_u32 v15, 7, v17
    s_waitcnt vmcnt(28)
    ds_write_b32 v14, v15
    s_sub_u32 s13, s13, 1
    s_cmp_lg_u32 s13, 0
    s_cbranch_scc1 L_seg28
    s_setpc_b64 s[52:53]
L_ldA2:
    v_lshl_add_u32 v8, v4, 12, v5
    v_xor_b32 v9, 0x80, v8
    v_add_u32 v10, 30720, v8
    v_add_u32 v11, 46080, v9
    v_add_u32 v9, 15360, v9
    s_mov_b64 s[8:9], s[20:21]
    s_mov_b32 s13, 4
    s_branch L_ld_rest
L_ld_notA:
    s_lshr_b32 s4, s2, 2
    s_xor_b32 s4, s4, s2
    s_and_b32 s4, s4, 4
    s_mul_i32 s4, s4, 5
    s_xor_b32 s4, s4, s2
    s_cmpk_ge_u32 s2, 224
    s_cselect_b32 s97, s4, s2
    s_cmpk_ge_u32 s97, 240
    s_cbranch_scc0 L_ld_G
    s_waitcnt lgkmcnt(0)
    s_barrier
Llw_1:
    ds_read_b32 v16, v14 offset:44
    s_waitcnt lgkmcnt(0)
    v_readfirstlane_b32 s13, v16
    s_cmp_ge_u32 s13, 4
    s_cbranch_scc1 Llw_1_ok
    s_sub_u32 s46, s46, 1
    s_cbranch_scc1 L_end
    s_sleep 4
    s_branch Llw_1
Llw_1_ok:
    s_branch L_ld_F2
L_ld_G:
    v_and_b32 v1, 7, v0
    v_lshlrev_b32 v1, 11, v1
    v_lshrrev_b32 v2, 3, v0
    v_lshl_add_u32 v12, v2, 4, v1
    v_mul_u32_u24 v2, 7168, v4
    v_add_u32 v8, v2, v5
    v_xor_b32 v9, 0x80, v8
    v_add_u32 v10, 55296, v8
    v_add_u32 v11, 82944, v9
    v_add_u32 v9, 27648, v9
    s_bfe_u32 s6, s2, 0x10001
    s_lshl_b32 s5, s6, 10
    s_mul_i32 s6, s6, 3670016
    s_sub_u32 s4, s97, 176
    s_lshr_b32 s12, s4, 2
    s_and_b32 s12, s12, 12
    s_lshr_b32 s12, 0x3201, s12
    s_and_b32 s12, s12, 3
    s_and_b32 s4, s4, 12
    s_add_u32 s12, s12, s4
    s_add_u32 s12, s12, 12
    s_bfe_u32 s4, s97, 0x50002
    s_xor_b32 s4, s4, 1
    s_cmp_lt_u32 s4, 12
    s_cselect_b32 s4, s4, s12
    s_lshl_b32 s12, s4, 8
    s_add_u32 s12, s12, s6
    s_mov_b32 m0, 135168
    s_waitcnt lgkmcnt(0)
    s_mov_b64 s[8:9], s[16:17]
    s_mov_b32 s10, 16384
    s_barrier
L_xh:
    buffer_load_dwordx4 v12, s[8:11], s5 offen lds
    s_add_u32 m0, m0, 1024
    s_add_u32 s5, s5, 128
    s_cmp_lt_u32 m0, 143360
    s_cbranch_scc1 L_xh
    s_bitcmp0_b32 s2, 0
    s_cselect_b32 s8, s28, s30
    s_cselect_b32 s9, s29, s31
    s_mov_b32 s10, 7340032
    s_mov_b32 m0, 32768
    s_mov_b32 s14, 114688
    s_mov_b32 s13, 20
    s_cmpk_ge_u32 s2, 224
    s_cbranch_scc0 L_ld_rest
    s_call_b64 s[52:53], L_seg28
    s_branch L_ld_rest2
L_ld_rest:
    s_call_b64 s[52:53], L_sel20_24
L_ld_rest2:
    ds_read_b32 v18, v14 offset:16
    s_mov_b32 s13, 4
    s_call_b64 s[52:53], L_seg20
    s_waitcnt lgkmcnt(1)
    v_readfirstlane_b32 s13, v18
    s_cmp_ge_u32 s13, 4
    s_cbranch_scc1 Llc_2
Llw_3:
    ds_read_b32 v16, v14 offset:16
    s_waitcnt lgkmcnt(0)
    v_readfirstlane_b32 s13, v16
    s_cmp_ge_u32 s13, 4
    s_cbranch_scc1 Llw_3_ok
    s_sub_u32 s46, s46, 1
    s_cbranch_scc1 L_end
    s_sleep 1
    s_branch Llw_3
Llw_3_ok:
Llc_2:
    s_mov_b32 m0, 0
    s_mov_b32 s13, 5
    s_call_b64 s[52:53], L_seg20
    ds_read_b32 v18, v14 offset:20
    s_mov_b32 s13, 3
    s_call_b64 s[52:53], L_seg20
    s_mov_b32 s7, -1
    s_waitcnt lgkmcnt(1)
    v_readfirstlane_b32 s13, v18
    s_cmp_ge_u32 s13, 4
    s_cbranch_scc1 Llc_4
Llw_5:
    ds_read_b32 v16, v14 offset:20
    s_waitcnt lgkmcnt(0)
    v_readfirstlane_b32 s13, v16
    s_cmp_ge_u32 s13, 4
    s_cbranch_scc1 Llw_5_ok
    s_sub_u32 s46, s46, 1
    s_cbranch_scc1 L_end
    s_sleep 1
    s_branch Llw_5
Llw_5_ok:
Llc_4:
L_ld_F2:
    v_lshl_add_u32 v8, v4, 11, v5
    v_xor_b32 v9, 0x80, v8
    v_add_u32 v10, 14336, v8
    v_add_u32 v11, 21504, v9
    v_add_u32 v9, 7168, v9
    s_mov_b64 s[8:9], s[32:33]
    s_mov_b32 s10, 7340032
    s_lshl_b32 s5, s55, 2
    s_lshr_b32 s5, 0x76432051, s5
    s_and_b32 s5, s5, 7
    s_lshl_b32 s5, s5, 8
    s_mul_i32 s12, s54, 229376
    s_add_u32 s12, s12, s5
    s_mov_b32 m0, 32768
    s_mov_b32 s14, 32768
    s_mov_b32 s13, 7
    s_call_b64 s[52:53], L_seg20
    s_mov_b64 s[8:9], s[24:25]
    s_mov_b32 s10, 8388608
    s_lshl_b32 s12, s54, 18
    s_add_u32 s12, s12, s5
    s_mov_b32 s13, 8
    s_call_b64 s[52:53], L_seg20
    v_subrev_u32 v20, 4, v17
    s_waitcnt vmcnt(16)
    ds_write_b32 v14, v20
    v_subrev_u32 v21, 3, v17
    s_waitcnt vmcnt(12)
    ds_write_b32 v14, v21
    v_subrev_u32 v22, 2, v17
    s_waitcnt vmcnt(8)
    ds_write_b32 v14, v22
    v_subrev_u32 v23, 1, v17
    s_waitcnt vmcnt(4)
    ds_write_b32 v14, v23
    v_subrev_u32 v24, 0, v17
    s_waitcnt vmcnt(0)
    ds_write_b32 v14, v24
    s_endpgm
L_helper:
    v_and_b32 v0, 63, v0
    s_and_b32 s54, s2, 31
    s_lshr_b32 s55, s2, 5
    s_mov_b32 s46, 400000
    v_mov_b32 v16, 154112
    s_waitcnt lgkmcnt(0)
    s_mov_b64 s[4:5], s[40:41]
    s_mov_b32 s6, 1589248
    s_mov_b32 s7, 0x20000
    s_cmp_lg_u32 s2, 0
    s_cbranch_scc1 L_nprobe
    s_cmpk_lt_u32 s3, 384
    s_cbranch_scc1 L_nprobe
    s_lshl_b32 s12, s3, 1
    s_add_u32 s12, s12, 266496
    s_add_u32 s13, s12, 8192
    s_load_dword s8, s[40:41], s12 glc
    s_load_dword s9, s[40:41], s13 glc
    s_mov_b32 s14, 0
    s_mov_b32 s15, 0
    s_waitcnt lgkmcnt(0)
    s_memtime s[16:17]
    s_waitcnt lgkmcnt(0)
    s_load_dword s8, s[40:41], s12 glc
    s_waitcnt lgkmcnt(0)
    s_memtime s[18:19]
    s_waitcnt lgkmcnt(0)
    s_sub_u32 s8, s16, s18
    s_max_u32 s14, s14, s8
    s_memtime s[16:17]
    s_waitcnt lgkmcnt(0)
    s_load_dword s8, s[40:41], s13 glc
    s_waitcnt lgkmcnt(0)
    s_memtime s[18:19]
    s_waitcnt lgkmcnt(0)
    s_sub_u32 s8, s16, s18
    s_max_u32 s15, s15, s8
    s_memtime s[16:17]
    s_waitcnt lgkmcnt(0)
    s_load_dword s8, s[40:41], s12 glc
    s_waitcnt lgkmcnt(0)
    s_memtime s[18:19]
    s_waitcnt lgkmcnt(0)
    s_sub_u32 s8, s16, s18
    s_max_u32 s14, s14, s8
    s_memtime s[16:17]
    s_waitcnt lgkmcnt(0)
    s_load_dword s8, s[40:41], s13 glc
    s_waitcnt lgkmcnt(0)
    s_memtime s[18:19]
    s_waitcnt lgkmcnt(0)
    s_sub_u32 s8, s16, s18
    s_max_u32 s15, s15, s8
L_nprobe:
    s_lshr_b32 s8, s2, 2
    s_xor_b32 s8, s8, s2
    s_and_b32 s8, s8, 4
    s_mul_i32 s8, s8, 5
    s_xor_b32 s8, s8, s2
    s_cmpk_ge_u32 s2, 224
    s_cselect_b32 s97, s8, s2
    s_mov_b32 s26, 0xff00ff00
    s_mov_b32 s27, 0xff00ff00
    s_mov_b32 s24, 0x20000000
    s_mov_b32 s25, 0x20000000
    s_mov_b32 s44, 0x5f000000
    s_mov_b32 s45, 0x5f000000
    s_mov_b32 s38, 0xbfff
    s_mov_b32 s39, 0xbfff0000
    s_mov_b32 s59, 0xbfffbfff
L_ep:
    ds_read_b64 v[2:3], v16 offset:48
    s_waitcnt lgkmcnt(0)
    v_readfirstlane_b32 s56, v2
    v_readfirstlane_b32 s47, v3
    s_cmp_lg_u32 s56, 0
    s_cbranch_scc1 L_ep_ok
    s_sub_u32 s46, s46, 1
    s_cbranch_scc1 L_end
    s_sleep 4
    s_branch L_ep
L_ep_ok:
    s_add_u32 s56, s47, 0
    s_and_b32 s57, s56, 1
    s_lshl_b32 s57, s57, 14
    s_and_b32 s56, s56, 2
    s_lshl_b32 s56, s56, 29
    s_or_b32 s28, s56, s57
    s_add_u32 s56, s47, 1
    s_and_b32 s57, s56, 1
    s_lshl_b32 s57, s57, 14
    s_and_b32 s56, s56, 2
    s_lshl_b32 s56, s56, 29
    s_or_b32 s29, s56, s57
    s_add_u32 s56, s47, 2
    s_and_b32 s57, s56, 1
    s_lshl_b32 s57, s57, 14
    s_and_b32 s56, s56, 2
    s_lshl_b32 s56, s56, 29
    s_or_b32 s30, s56, s57
    s_add_u32 s56, s47, 3
    s_and_b32 s57, s56, 1
    s_lshl_b32 s57, s57, 14
    s_and_b32 s56, s56, 2
    s_lshl_b32 s56, s56, 29
    s_or_b32 s31, s56, s57
    s_cmpk_ge_u32 s3, 384
    s_cbranch_scc1 L_fw
    s_and_b32 s12, s54, 24
    s_and_b32 s8, s54, 3
    s_lshl1_add_u32 s12, s8, s12
    s_bfe_u32 s8, s54, 0x10002
    s_add_u32 s12, s12, s8
    s_lshl_b32 s12, s12, 13
    s_and_b32 s8, s2, 128
    s_add_u32 s12, s12, s8
    s_add_u32 s12, s12, 262144
    s_mul_i32 s8, s54, 7
    s_add_u32 s9, s8, 6
    s_xor_b32 s8, s8, s9
    s_cmp_ge_u32 s8, 8
    s_cselect_b32 s14, 8, 4
    s_cmpk_ge_u32 s97, 240
    s_cselect_b32 s15, 15, 30
    s_cselect_b32 s18, 15, 22
    s_cselect_b32 s13, 34, 18
    s_cselect_b32 s49, 14, 46
    v_mov_b32 v2, 0
    s_and_b32 s50, s55, 3
    s_lshl_b32 s50, s50, 16
    s_and_b32 s8, s2, 128
    s_add_u32 s50, s50, s8
    s_add_u32 s50, s50, 266240
    v_and_b32 v13, 24, v0
    v_and_b32 v3, 3, v0
    v_lshl_add_u32 v13, v3, 1, v13
    v_bfe_u32 v3, v0, 2, 1
    v_add_lshl_u32 v13, v13, v3, 13
    s_and_b32 s8, s2, 0x60
    s_cbranch_scc1 L_h_nz
    v_lshlrev_b32 v3, 8, v0
    s_mov_b64 exec, 31
    buffer_store_dword v2, v3, s[4:7], s12 offen sc1
L_h_nz:
    s_cmp_lg_u32 s54, 0
    s_cbranch_scc1 L_h_nz2
    s_mov_b64 exec, 0xff
    buffer_store_dword v2, v13, s[4:7], s50 offen sc1
L_h_nz2:
    s_mov_b64 exec, -1
    s_lshl_b32 s43, s55, 2
    s_lshr_b32 s43, 0x76432051, s43
    s_and_b32 s43, s43, 7
    s_lshl_b32 s43, s43, 8
    s_lshl_b32 s57, s2, 11
    s_add_u32 s57, s57, 1048576
    v_lshlrev_b32 v44, 4, v0
    v_add_u32 v44, s57, v44
    s_lshr_b32 s57, s54, 2
    s_lshl_b32 s57, s57, 11
    s_add_u32 s43, s43, s57
    s_and_b32 s57, s54, 3
    s_lshl_b32 s57, s57, 6
    s_add_u32 s43, s43, s57
    v_lshrrev_b32 v1, 4, v0
    v_and_b32 v45, 3, v0
    v_lshlrev_b32 v45, 4, v45
    v_lshl_add_u32 v45, v1, 2, v45
    s_and_b32 s9, s2, 7
    s_and_b32 s42, s9, 24
    s_and_b32 s8, s9, 3
    s_lshl1_add_u32 s42, s8, s42
    s_bfe_u32 s8, s9, 0x10002
    s_add_u32 s42, s42, s8
    s_lshl_b32 s42, s42, 13
    s_add_u32 s42, s42, s50
    v_mov_b32 v14, 1581568
    s_mov_b32 exec_hi, 0
    s_lshr_b32 s8, s54, 3
    s_lshl_b32 s8, s8, 11
    s_and_b32 s9, s54, 7
    s_lshl3_add_u32 s8, s9, s8
    s_add_u32 s8, s8, 1572864
    v_lshlrev_b32 v3, 6, v0
    v_add_u32 v3, s8, v3
    v_lshrrev_b32 v5, 2, v0
    v_lshlrev_b32 v4, 6, v5
    v_add_u32 v4, 1581056, v4
    v_and_b32 v6, 3, v0
    v_lshlrev_b32 v5, 5, v5
    v_add_u32 v5, 153856, v5
    v_lshl_add_u32 v6, v6, 2, v5
    s_mov_b64 s[8:9], s[36:37]
    s_movk_i32 s10, 0x4000
Lsy_6:
    ds_read_b32 v1, v16 offset:0
    s_waitcnt lgkmcnt(0)
    v_readfirstlane_b32 s56, v1
    s_cmp_ge_i32 s56, s18
    s_cbranch_scc1 Lsy_6_ok
    s_sub_u32 s46, s46, 1
    s_cbranch_scc1 L_end
    s_sleep 4
    s_branch Lsy_6
Lsy_6_ok:
L_h_g:
    buffer_load_dwordx2 v[8:9], v4, s[4:7], 0 offen sc1
    buffer_load_dwordx2 v[10:11], v14, s[4:7], 0 offen sc1
    s_waitcnt vmcnt(0)
    v_xor_b32 v7, s47, v9
    v_bitop3_b32 v7, v11, s47, v7 bitop3:0xbe
    v_cmp_ne_u32 vcc, 0, v7
    s_cbranch_vccz L_h_g_ok
    s_sub_u32 s46, s46, 1
    s_cbranch_scc1 L_end
    s_sleep 4
    s_branch L_h_g
L_h_g_ok:
    v_and_b32 v11, 0x2000, v10
    v_mov_b32 v10, 1
    ds_write_b64 v16, v[10:11] offset:64
    v_readfirstlane_b32 s57, v11
    s_xor_b32 s12, s12, s57
    s_xor_b32 s42, s42, s57
    s_add_u32 s16, s40, s12
    s_addc_u32 s17, s41, 0
    s_mov_b32 exec_hi, -1
    v_xor_b32 v13, s57, v13
    v_xor_b32 v44, s57, v44
    s_mov_b32 exec_hi, 0
    v_sub_f32 v12, 1.0, v8
    v_mul_f32 v8, s44, v8
    v_cvt_pk_bf16_f32 v12, v12, v12
    v_lshlrev_b32 v12, 16, v12
    v_mul_f32 v12, s44, v12
    ds_write_b32 v5, v12 offset:16
Lsy_7:
    ds_read_b32 v1, v16 offset:0
    s_waitcnt lgkmcnt(0)
    v_readfirstlane_b32 s56, v1
    s_cmp_ge_i32 s56, s15
    s_cbranch_scc1 Lsy_7_ok
    s_sub_u32 s46, s46, 1
    s_cbranch_scc1 L_end
    s_sleep 2
    s_branch Lsy_7
Lsy_7_ok:
    v_mov_b32 v12, 1
    s_mov_b32 s18, 0
L_hq:
    s_load_dword s19, s[16:17], 0 glc
    s_load_dword s20, s[16:17], 256 glc
    s_load_dword s21, s[16:17], 512 glc
    s_load_dword s22, s[16:17], 768 glc
    s_load_dword s23, s[16:17], 1024 glc
    s_sub_u32 s13, s13, 1
    s_cselect_b32 s12, 0, 8
    s_cselect_b32 s14, 0, s14
    s_waitcnt lgkmcnt(0)
    s_cmp_lt_u32 s23, s14
    s_cbranch_scc1 L_hq_a
    ds_write_b32 v16, v12 offset:8
    s_bitset1_b32 s18, 0
L_hq_a:
    s_min_u32 s19, s19, s20
    s_min_u32 s21, s21, s22
    s_min_u32 s19, s19, s21
    s_cmp_lt_u32 s19, s12
    s_cbranch_scc1 L_hq_b
    s_bitcmp1_b32 s18, 1
    s_cbranch_scc1 L_hq_c
    buffer_load_dwordx2 v[10:11], v3, s[4:7], 0 offen sc1
    ds_write_b32 v16, v12 offset:12
    s_bitset1_b32 s18, 1
    s_branch L_hq_d
L_hq_b:
    s_cmp_ge_u32 s19, 5
    s_cbranch_scc1 L_hq
    s_sleep 8
    s_branch L_hq
L_hq_c:
    s_bitcmp1_b32 s18, 2
    s_cbranch_scc1 L_hq_d
    s_call_b64 s[52:53], L_wts
L_hq_d:
    s_bitcmp1_b32 s18, 0
    s_cbranch_scc0 L_hq
    s_bitcmp1_b32 s18, 2
    s_cbranch_scc1 L_hq_e
    s_call_b64 s[52:53], L_wts
L_hq_e:
    s_mov_b32 s15, 12
Lsy_8:
    ds_read_b32 v1, v16 offset:36
    s_waitcnt lgkmcnt(0)
    v_readfirstlane_b32 s56, v1
    s_cmp_ge_u32 s56, 8
    s_cbranch_scc1 Lsy_8_ok
    s_sub_u32 s46, s46, 1
    s_cbranch_scc1 L_end
    s_branch Lsy_8
Lsy_8_ok:
Lsy_9:
    ds_read_b32 v1, v16 offset:0
    s_waitcnt lgkmcnt(0)
    v_readfirstlane_b32 s56, v1
    s_cmp_ge_i32 s56, s49
    s_cbranch_scc1 Lsy_9_ok
    s_sub_u32 s46, s46, 1
    s_cbranch_scc1 L_end
    s_branch Lsy_9
Lsy_9_ok:
    s_mov_b64 exec, 0xff
    buffer_atomic_add v12, v13, s[4:7], s50 offen sc1
    s_mov_b64 exec, -1
L_hf:
    s_load_dword s20, s[40:41], s42 glc
    s_sub_u32 s15, s15, 1
    s_cbranch_scc1 L_hf_go
    s_waitcnt lgkmcnt(0)
    s_cmp_lt_u32 s20, 32
    s_cbranch_scc1 L_hf
L_hf_go:
    buffer_load_dwordx4 v[48:51], v44, s[4:7], 0 offen sc1
    buffer_load_dwordx4 v[52:55], v44, s[4:7], 0 offen offset:1024 sc1
L_rg:
    s_waitcnt vmcnt(0)
    v_xor_b32 v1, s28, v48
    v_xor_b32 v2, s28, v52
    v_bitop3_b32 v1, v49, s29, v1 bitop3:0xbe
    v_bitop3_b32 v2, v53, s29, v2 bitop3:0xbe
    v_bitop3_b32 v1, v50, s30, v1 bitop3:0xbe
    v_bitop3_b32 v2, v54, s30, v2 bitop3:0xbe
    v_bitop3_b32 v1, v51, s31, v1 bitop3:0xbe
    v_bitop3_b32 v2, v55, s31, v2 bitop3:0xbe
    v_bitop3_b32 v1, v1, v2, s59 bitop3:0x54
    s_nop 1
    v_or_b32_dpp v1, v1, v1 quad_perm:[1,0,3,2] row_mask:0xf bank_mask:0xf
    s_nop 1
    v_or_b32_dpp v1, v1, v1 quad_perm:[2,3,0,1] row_mask:0xf bank_mask:0xf
    v_cmpx_ne_u32 vcc, 0, v1
    s_cbranch_execz L_rg_ok
    s_sub_u32 s46, s46, 1
    s_cbranch_scc1 L_end
    buffer_load_dwordx4 v[48:51], v44, s[4:7], 0 offen sc1
    buffer_load_dwordx4 v[52:55], v44, s[4:7], 0 offen offset:1024 sc1
    s_branch L_rg
L_rg_ok:
    s_mov_b64 exec, -1
    v_and_b32_sdwa v24, v48, s38 dst_sel:WORD_1 dst_unused:UNUSED_PAD src0_sel:WORD_0 src1_sel:DWORD
    v_and_b32 v25, s39, v48
    v_and_b32_sdwa v26, v49, s38 dst_sel:WORD_1 dst_unused:UNUSED_PAD src0_sel:WORD_0 src1_sel:DWORD
    v_and_b32 v27, s39, v49
    v_and_b32_sdwa v28, v50, s38 dst_sel:WORD_1 dst_unused:UNUSED_PAD src0_sel:WORD_0 src1_sel:DWORD
    v_and_b32 v29, s39, v50
    v_and_b32_sdwa v30, v51, s38 dst_sel:WORD_1 dst_unused:UNUSED_PAD src0_sel:WORD_0 src1_sel:DWORD
    v_and_b32 v31, s39, v51
    v_and_b32_sdwa v32, v52, s38 dst_sel:WORD_1 dst_unused:UNUSED_PAD src0_sel:WORD_0 src1_sel:DWORD
    v_and_b32 v33, s39, v52
    v_and_b32_sdwa v34, v53, s38 dst_sel:WORD_1 dst_unused:UNUSED_PAD src0_sel:WORD_0 src1_sel:DWORD
    v_and_b32 v35, s39, v53
    v_and_b32_sdwa v36, v54, s38 dst_sel:WORD_1 dst_unused:UNUSED_PAD src0_sel:WORD_0 src1_sel:DWORD
    v_and_b32 v37, s39, v54
    v_and_b32_sdwa v38, v55, s38 dst_sel:WORD_1 dst_unused:UNUSED_PAD src0_sel:WORD_0 src1_sel:DWORD
    v_and_b32 v39, s39, v55
    v_pk_add_f32 v[24:25], v[24:25], v[32:33]
    v_pk_add_f32 v[26:27], v[26:27], v[34:35]
    v_pk_add_f32 v[28:29], v[28:29], v[36:37]
    v_pk_add_f32 v[30:31], v[30:31], v[38:39]
    s_nop 0
    v_permlane32_swap_b32 v24, v28
    v_permlane32_swap_b32 v25, v29
    v_permlane32_swap_b32 v26, v30
    v_permlane32_swap_b32 v27, v31
    v_pk_add_f32 v[24:25], v[24:25], v[28:29]
    v_pk_add_f32 v[26:27], v[26:27], v[30:31]
    s_nop 1
    v_permlane16_swap_b32 v24, v26
    v_permlane16_swap_b32 v25, v27
    v_pk_add_f32 v[24:25], v[24:25], v[26:27]
    s_nop 1
    v_add_f32_dpp v24, v24, v24 row_ror:8 row_mask:0xf bank_mask:0xf
    v_add_f32_dpp v25, v25, v25 row_ror:8 row_mask:0xf bank_mask:0xf
    s_nop 0
    v_add_f32_dpp v24, v24, v24 row_ror:4 row_mask:0xf bank_mask:0xf
    v_add_f32_dpp v25, v25, v25 row_ror:4 row_mask:0xf bank_mask:0xf
    s_mov_b32 exec_lo, 0x000f000f
    s_mov_b32 exec_hi, 0x000f000f
    v_pk_mul_f32 v[24:25], v[24:25], s[44:45]
    v_cvt_pk_bf16_f32 v24, v24, v25
    buffer_store_dword v24, v45, s[8:11], s43 offen
    s_cmp_lg_u32 s2, 0
    s_cbranch_scc1 L_noep
    s_mov_b64 exec, 1
    v_mov_b32 v1, 268288
    v_mov_b32 v2, s47
    buffer_store_dword v2, v1, s[4:7], 0 offen
L_noep:
    s_endpgm
L_wts:
    s_waitcnt vmcnt(0)
    v_cmp_ne_u32 vcc, s47, v11
    s_cbranch_vccz L_wts_ok
    s_sub_u32 s46, s46, 1
    s_cbranch_scc1 L_end
    buffer_load_dwordx2 v[10:11], v3, s[4:7], 0 offen sc1
    s_branch L_wts
L_wts_ok:
    v_max_f32_dpp v7, v10, v10 quad_perm:[1,0,3,2] row_mask:0xf bank_mask:0xf
    s_bitset1_b32 s18, 2
    s_nop 0
    v_max_f32_dpp v7, v7, v7 quad_perm:[2,3,0,1] row_mask:0xf bank_mask:0xf
    v_sub_f32 v10, v10, v7
    v_exp_f32 v10, v10
    s_nop 1
    v_add_f32_dpp v7, v10, v10 quad_perm:[1,0,3,2] row_mask:0xf bank_mask:0xf
    v_mul_f32 v10, v10, v8
    s_nop 0
    v_add_f32_dpp v7, v7, v7 quad_perm:[2,3,0,1] row_mask:0xf bank_mask:0xf
    v_rcp_f32 v7, v7
    s_nop 0
    v_mul_f32 v10, v10, v7
    ds_write_b32 v6, v10
    ds_write_b32 v16, v12 offset:40
    s_setpc_b64 s[52:53]
L_fw:
    s_lshr_b32 s3, s3, 6
    s_sub_u32 s3, s3, 6
    v_and_b32 v19, 7, v0
    v_lshrrev_b32 v1, 2, v0
    v_and_b32 v5, 7, v1
    v_lshlrev_b32 v5, 1, v5
    v_bfe_u32 v6, v0, 1, 1
    s_lshl_b32 s42, s3, 2
    v_add_u32 v6, s42, v6
    v_xor_b32 v6, v6, v5
    v_lshlrev_b32 v6, 4, v6
    v_lshl_add_u32 v6, v1, 8, v6
    v_and_b32 v5, 1, v0
    v_lshl_add_u32 v10, v5, 3, v6
    v_lshrrev_b32 v1, 5, v0
    v_lshlrev_b32 v1, 7, v1
    v_lshl_add_u32 v1, v19, 4, v1
    v_bfe_u32 v5, v0, 4, 1
    v_lshl_add_u32 v11, v5, 3, v1
    s_lshl_b32 s56, s55, 16
    s_lshl_b32 s57, s3, 11
    s_add_u32 s56, s56, s57
    s_lshl_b32 s57, s54, 6
    s_add_u32 s56, s56, s57
    s_add_u32 s56, s56, 1048576
    v_and_b32 v1, 8, v0
    v_lshlrev_b32 v1, 2, v1
    v_lshrrev_b32 v2, 4, v0
    v_lshl_add_u32 v1, v2, 3, v1
    v_lshl_add_u32 v1, v19, 13, v1
    v_add_u32 v15, s56, v1
    v_add_u32 v20, 32768, v10
    v_xor_b32 v21, 32, v20
    v_add_u32 v22, 147456, v11
    v_add_u32 v47, 149504, v11
    v_lshrrev_b32 v8, 5, v0
    v_bfe_u32 v3, v0, 2, 3
    v_bfe_u32 v4, v0, 1, 1
    v_and_b32 v5, 1, v0
    v_lshlrev_b32 v6, 4, v3
    v_lshl_add_u32 v6, v5, 7, v6
    v_lshl_add_u32 v6, v8, 3, v6
    s_lshl_b32 s57, s3, 1
    v_add_u32 v7, s57, v4
    v_min_u32 v9, 6, v7
    v_lshl_add_u32 v1, v9, 8, v6
    v_add_u32 v12, 147456, v1
    v_lshlrev_b32 v2, 5, v3
    v_add_u32 v13, 153856, v2
    v_lshl_add_u32 v2, v9, 8, v2
    v_lshl_add_u32 v2, v5, 4, v2
    v_mul_u32_u24 v1, 1792, v8
    v_add_u32 v2, v2, v1
    s_and_b32 s56, s54, 24
    s_and_b32 s57, s54, 3
    s_lshl1_add_u32 s56, s57, s56
    s_bfe_u32 s57, s54, 0x10002
    s_add_u32 s56, s56, s57
    s_lshl_b32 s56, s56, 13
    s_add_u32 s56, s56, 524288
    v_add_u32 v46, s56, v2
    s_cmpk_ge_u32 s97, 240
    s_cselect_b32 s49, 0, 32
    s_cselect_b32 s58, 0, 30
    s_mov_b32 s48, 0
    s_mov_b32 s62, 0
    s_mov_b32 s63, 0
    v_mov_b32 v122, 0
    v_mov_b32 v123, 0
    v_mov_b32 v126, 0
    v_mov_b32 v127, 0
    v_mov_b32 v158, 0
    v_mov_b32 v159, 0
    v_and_b32 v5, 16, v0
    v_cmp_ne_u32 vcc, 0, v5
    v_mov_b32 v1, s28
    v_mov_b32 v2, s30
    v_cndmask_b32 v44, v1, v2, vcc
    v_mov_b32 v1, s29
    v_mov_b32 v2, s31
    v_cndmask_b32 v45, v1, v2, vcc
    s_cmp_lg_u32 s2, 0
    s_cbranch_scc1 L_f_np
    v_mov_b32 v2, s14
    v_mov_b32 v3, s15
    v_mov_b32 v1, 1
    s_mov_b64 exec, 1
    ds_max_u32 v16, v2 offset:72
    ds_max_u32 v16, v3 offset:76
    ds_add_rtn_u32 v4, v16, v1 offset:80
    ds_read_b64 v[2:3], v16 offset:72
    s_waitcnt lgkmcnt(0)
    v_readfirstlane_b32 s14, v4
    v_cmp_lt_u32 vcc, v2, v3
    v_mov_b32 v5, 0x2000
    s_cmp_lg_u32 s14, 3
    v_cndmask_b32 v2, 0, v5, vcc
    s_cbranch_scc1 L_f_np
    v_mov_b32 v3, s47
    v_mov_b32 v1, 1581568
    buffer_store_dwordx2 v[2:3], v1, s[4:7], 0 offen sc1
L_f_np:
    s_mov_b64 exec, -1
Lsy_10:
    ds_read_b32 v1, v16 offset:0
    s_waitcnt lgkmcnt(0)
    v_readfirstlane_b32 s56, v1
    s_cmp_ge_i32 s56, s58
    s_cbranch_scc1 Lsy_10_ok
    s_sub_u32 s46, s46, 1
    s_cbranch_scc1 L_end
    s_sleep 8
    s_branch Lsy_10
Lsy_10_ok:
Lsd_11:
    ds_read_b64 v[2:3], v16 offset:64
    s_waitcnt lgkmcnt(0)
    v_readfirstlane_b32 s56, v2
    v_readfirstlane_b32 s57, v3
    s_cmp_lg_u32 s56, 0
    s_cbranch_scc1 Lsd_11_ok
    s_sub_u32 s46, s46, 1
    s_cbranch_scc1 L_end
    s_sleep 1
    s_branch Lsd_11
Lsd_11_ok:
    v_xor_b32 v46, s57, v46
    v_xor_b32 v15, s57, v15
    s_add_u32 s49, s49, 1
    s_cmp_ge_i32 s48, s49
    s_cbranch_scc1 Lpre_12
    s_call_b64 s[52:53], L_pwf
Lpre_12:
    ds_read_b64_tr_b16 v[64:65], v20 offset:0
    ds_read_b64_tr_b16 v[68:69], v21 offset:0
    s_add_u32 s49, s49, 1
    s_cmp_ge_i32 s48, s49
    s_cbranch_scc1 Lpre_13
    s_call_b64 s[52:53], L_pwf
Lpre_13:
    ds_read_b64_tr_b16 v[66:67], v20 offset:4096
    ds_read_b64_tr_b16 v[70:71], v21 offset:4096
    s_add_u32 s49, s49, 1
    s_cmp_ge_i32 s48, s49
    s_cbranch_scc1 Lpre_14
    s_call_b64 s[52:53], L_pwf
Lpre_14:
    ds_read_b64_tr_b16 v[72:73], v20 offset:8192
    ds_read_b64_tr_b16 v[76:77], v21 offset:8192
    s_add_u32 s49, s49, 1
    s_cmp_ge_i32 s48, s49
    s_cbranch_scc1 Lpre_15
    s_call_b64 s[52:53], L_pwf
Lpre_15:
    ds_read_b64_tr_b16 v[74:75], v20 offset:12288
    ds_read_b64_tr_b16 v[78:79], v21 offset:12288
    s_add_u32 s49, s49, 1
    s_cmp_ge_i32 s48, s49
    s_cbranch_scc1 Lpre_16
    s_call_b64 s[52:53], L_pwf
Lpre_16:
    ds_read_b64_tr_b16 v[80:81], v20 offset:16384
    ds_read_b64_tr_b16 v[84:85], v21 offset:16384
    s_add_u32 s49, s49, 1
    s_cmp_ge_i32 s48, s49
    s_cbranch_scc1 Lpre_17
    s_call_b64 s[52:53], L_pwf
Lpre_17:
    ds_read_b64_tr_b16 v[82:83], v20 offset:20480
    ds_read_b64_tr_b16 v[86:87], v21 offset:20480
    s_add_u32 s49, s49, 1
    s_cmp_ge_i32 s48, s49
    s_cbranch_scc1 Lpre_18
    s_call_b64 s[52:53], L_pwf
Lpre_18:
    ds_read_b64_tr_b16 v[88:89], v20 offset:24576
    ds_read_b64_tr_b16 v[92:93], v21 offset:24576
    s_add_u32 s49, s49, 1
    s_cmp_ge_i32 s48, s49
    s_cbranch_scc1 Lpre_19
    s_call_b64 s[52:53], L_pwf
Lpre_19:
    ds_read_b64_tr_b16 v[90:91], v20 offset:28672
    ds_read_b64_tr_b16 v[94:95], v21 offset:28672
    s_add_u32 s49, s49, 1
    s_cmp_ge_i32 s48, s49
    s_cbranch_scc1 Lpre_20
    s_call_b64 s[52:53], L_pwf
Lpre_20:
    ds_read_b64_tr_b16 v[96:97], v20 offset:32768
    ds_read_b64_tr_b16 v[100:101], v21 offset:32768
    s_add_u32 s49, s49, 1
    s_cmp_ge_i32 s48, s49
    s_cbranch_scc1 Lpre_21
    s_call_b64 s[52:53], L_pwf
Lpre_21:
    ds_read_b64_tr_b16 v[98:99], v20 offset:36864
    ds_read_b64_tr_b16 v[102:103], v21 offset:36864
    s_add_u32 s49, s49, 1
    s_cmp_ge_i32 s48, s49
    s_cbranch_scc1 Lpre_22
    s_call_b64 s[52:53], L_pwf
Lpre_22:
    ds_read_b64_tr_b16 v[104:105], v20 offset:40960
    ds_read_b64_tr_b16 v[108:109], v21 offset:40960
    s_add_u32 s49, s49, 1
    s_cmp_ge_i32 s48, s49
    s_cbranch_scc1 Lpre_23
    s_call_b64 s[52:53], L_pwf
Lpre_23:
    ds_read_b64_tr_b16 v[106:107], v20 offset:45056
    ds_read_b64_tr_b16 v[110:111], v21 offset:45056
    s_add_u32 s49, s49, 1
    s_cmp_ge_i32 s48, s49
    s_cbranch_scc1 Lpre_24
Lpre_24_p:
    s_cmp_lg_u32 s62, 1
    s_cbranch_scc1 Lpre_24_q
    s_call_b64 s[60:61], L_mf6
Lpre_24_q:
    ds_read_b96 v[2:4], v16 offset:0
    ds_read_b64_tr_b16 v[112:113], v20 offset:49152
    ds_read_b64_tr_b16 v[116:117], v21 offset:49152
    s_waitcnt lgkmcnt(2)
    v_readfirstlane_b32 s48, v2
    s_cmp_eq_u32 s62, 2
    s_cbranch_scc1 Lpre_24_r
    s_call_b64 s[60:61], L_evt
Lpre_24_r:
    s_cmp_ge_i32 s48, s49
    s_cbranch_scc1 Lpre_24_d
    s_sub_u32 s46, s46, 1
    s_cbranch_scc1 L_end
    s_branch Lpre_24_p
Lpre_24:
    ds_read_b64_tr_b16 v[112:113], v20 offset:49152
    ds_read_b64_tr_b16 v[116:117], v21 offset:49152
Lpre_24_d:
    s_add_u32 s49, s49, 1
    s_cmp_ge_i32 s48, s49
    s_cbranch_scc1 Lpre_25
Lpre_25_p:
    s_cmp_lg_u32 s62, 1
    s_cbranch_scc1 Lpre_25_q
    s_call_b64 s[60:61], L_mf6
Lpre_25_q:
    ds_read_b96 v[2:4], v16 offset:0
    ds_read_b64_tr_b16 v[114:115], v20 offset:53248
    ds_read_b64_tr_b16 v[118:119], v21 offset:53248
    s_waitcnt lgkmcnt(2)
    v_readfirstlane_b32 s48, v2
    s_cmp_eq_u32 s62, 2
    s_cbranch_scc1 Lpre_25_r
    s_call_b64 s[60:61], L_evt
Lpre_25_r:
    s_cmp_ge_i32 s48, s49
    s_cbranch_scc1 Lpre_25_d
    s_sub_u32 s46, s46, 1
    s_cbranch_scc1 L_end
    s_branch Lpre_25_p
Lpre_25:
    ds_read_b64_tr_b16 v[114:115], v20 offset:53248
    ds_read_b64_tr_b16 v[118:119], v21 offset:53248
Lpre_25_d:
    s_add_u32 s49, s49, 1
    s_cmp_ge_i32 s48, s49
    s_cbranch_scc1 Lpre_26
Lpre_26_p:
    s_cmp_lg_u32 s62, 1
    s_cbranch_scc1 Lpre_26_q
    s_call_b64 s[60:61], L_mf6
Lpre_26_q:
    ds_read_b96 v[2:4], v16 offset:0
    ds_read_b64_tr_b16 v[120:121], v20 offset:57344
    ds_read_b64_tr_b16 v[124:125], v21 offset:57344
    s_waitcnt lgkmcnt(2)
    v_readfirstlane_b32 s48, v2
    s_cmp_eq_u32 s62, 2
    s_cbranch_scc1 Lpre_26_r
    s_call_b64 s[60:61], L_evt
Lpre_26_r:
    s_cmp_ge_i32 s48, s49
    s_cbranch_scc1 Lpre_26_d
    s_sub_u32 s46, s46, 1
    s_cbranch_scc1 L_end
    s_branch Lpre_26_p
Lpre_26:
    ds_read_b64_tr_b16 v[120:121], v20 offset:57344
    ds_read_b64_tr_b16 v[124:125], v21 offset:57344
Lpre_26_d:
    s_cmp_eq_u32 s62, 2
    s_cbranch_scc1 L_f_tail
    s_cmp_eq_u32 s62, 1
    s_cbranch_scc1 L_f_m
    s_cmp_eq_u32 s63, 2
    s_cbranch_scc1 L_f_u
    s_cmp_eq_u32 s63, 1
    s_cbranch_scc1 L_f_h
Lsy_27:
    ds_read_b32 v1, v16 offset:8
    s_waitcnt lgkmcnt(0)
    v_readfirstlane_b32 s56, v1
    s_cmp_ge_u32 s56, 1
    s_cbranch_scc1 Lsy_27_ok
    s_sub_u32 s46, s46, 1
    s_cbranch_scc1 L_end
    s_branch Lsy_27
Lsy_27_ok:
    buffer_load_dwordx4 v[24:27], v46, s[4:7], 0 offen sc1
    buffer_load_dwordx4 v[28:31], v46, s[4:7], 0 offen offset:3584 sc1
L_f_h:
    s_call_b64 s[60:61], L_hpart
L_f_u:
Lsy_28:
    ds_read_b32 v1, v16 offset:36
    s_waitcnt lgkmcnt(0)
    v_readfirstlane_b32 s56, v1
    s_cmp_ge_u32 s56, 8
    s_cbranch_scc1 Lsy_28_ok
    s_sub_u32 s46, s46, 1
    s_cbranch_scc1 L_end
    s_branch Lsy_28
Lsy_28_ok:
Lsp_29:
    ds_read_b32 v1, v16 offset:4
    ds_read2_b64 v[128:131], v22 offset0:0 offset1:32
    ds_read2_b64 v[132:135], v22 offset0:64 offset1:96
    ds_read2_b64 v[136:139], v22 offset0:128 offset1:160
    ds_read2_b64 v[140:143], v22 offset0:192 offset1:224
    ds_read2_b64 v[144:147], v47 offset0:0 offset1:32
    ds_read2_b64 v[148:151], v47 offset0:64 offset1:96
    ds_read2_b64 v[152:155], v47 offset0:128 offset1:160
    ds_read_b64 v[156:157], v22 offset:3584
    s_waitcnt lgkmcnt(8)
    v_readfirstlane_b32 s56, v1
    s_cmp_ge_u32 s56, 8
    s_cbranch_scc1 Lsp_29_ok
    s_sub_u32 s46, s46, 1
    s_cbranch_scc1 L_end
    s_branch Lsp_29
Lsp_29_ok:
    s_waitcnt lgkmcnt(7)
    v_mfma_f32_16x16x32_bf16 v[32:35], v[64:67], v[128:131], 0
    v_mfma_f32_16x16x32_bf16 v[36:39], v[68:71], v[128:131], 0
    s_waitcnt lgkmcnt(6)
    v_mfma_f32_16x16x32_bf16 v[32:35], v[72:75], v[132:135], v[32:35]
    v_mfma_f32_16x16x32_bf16 v[36:39], v[76:79], v[132:135], v[36:39]
    s_waitcnt lgkmcnt(5)
    v_mfma_f32_16x16x32_bf16 v[32:35], v[80:83], v[136:139], v[32:35]
    v_mfma_f32_16x16x32_bf16 v[36:39], v[84:87], v[136:139], v[36:39]
    s_waitcnt lgkmcnt(4)
    v_mfma_f32_16x16x32_bf16 v[32:35], v[88:91], v[140:143], v[32:35]
    v_mfma_f32_16x16x32_bf16 v[36:39], v[92:95], v[140:143], v[36:39]
    s_waitcnt lgkmcnt(3)
    v_mfma_f32_16x16x32_bf16 v[32:35], v[96:99], v[144:147], v[32:35]
    v_mfma_f32_16x16x32_bf16 v[36:39], v[100:103], v[144:147], v[36:39]
    s_waitcnt lgkmcnt(2)
    v_mfma_f32_16x16x32_bf16 v[32:35], v[104:107], v[148:151], v[32:35]
    v_mfma_f32_16x16x32_bf16 v[36:39], v[108:111], v[148:151], v[36:39]
    s_branch L_f_tail
L_f_m:
    s_call_b64 s[60:61], L_mf6
L_f_tail:
    s_waitcnt lgkmcnt(0)
    v_mfma_f32_16x16x32_bf16 v[32:35], v[112:115], v[152:155], v[32:35]
    v_mfma_f32_16x16x32_bf16 v[36:39], v[116:119], v[152:155], v[36:39]
    v_mfma_f32_16x16x32_bf16 v[32:35], v[120:123], v[156:159], v[32:35]
    v_mfma_f32_16x16x32_bf16 v[36:39], v[124:127], v[156:159], v[36:39]
    s_nop 7
    v_cndmask_b32 v40, v32, v36, s[26:27]
    v_cndmask_b32 v41, v33, v37, s[26:27]
    v_cndmask_b32 v42, v34, v38, s[26:27]
    v_cndmask_b32 v43, v35, v39, s[26:27]
    v_pk_mul_f32 v[40:41], v[40:41], s[24:25]
    v_pk_mul_f32 v[42:43], v[42:43], s[24:25]
    v_cvt_pk_bf16_f32 v40, v40, v41
    v_cvt_pk_bf16_f32 v41, v42, v43
    v_and_or_b32 v40, v40, s59, v44
    v_and_or_b32 v41, v41, s59, v45
    buffer_store_dwordx2 v[40:41], v15, s[4:7], 0 offen sc1
    s_endpgm
L_pwf:
    ds_read_b96 v[2:4], v16 offset:0
    s_waitcnt lgkmcnt(0)
    v_readfirstlane_b32 s48, v2
    s_call_b64 s[60:61], L_evt
    s_cmp_ge_i32 s48, s49
    s_cbranch_scc1 L_ret
    s_sub_u32 s46, s46, 1
    s_cbranch_scc1 L_end
    s_branch L_pwf
L_evt:
    s_cmp_eq_u32 s63, 2
    s_cbranch_scc1 L_evt2
    s_cmp_eq_u32 s63, 1
    s_cbranch_scc1 L_evt1
    v_readfirstlane_b32 s56, v4
    s_cmp_eq_u32 s56, 0
    s_cbranch_scc1 L_ret2
    buffer_load_dwordx4 v[24:27], v46, s[4:7], 0 offen sc1
    buffer_load_dwordx4 v[28:31], v46, s[4:7], 0 offen offset:3584 sc1
    s_mov_b32 s63, 1
    s_add_u32 s50, s48, 4
    s_setpc_b64 s[60:61]
L_evt1:
    s_cmp_ge_i32 s48, s50
    s_cbranch_scc1 L_hpart
    s_setpc_b64 s[60:61]
L_evt2:
    v_readfirstlane_b32 s56, v3
    s_lshr_b32 s56, s56, 3
    s_cmp_gt_u32 s56, s62
    s_cbranch_scc0 L_ret2
    ds_read2_b64 v[128:131], v22 offset0:0 offset1:32
    ds_read2_b64 v[132:135], v22 offset0:64 offset1:96
    ds_read2_b64 v[136:139], v22 offset0:128 offset1:160
    ds_read2_b64 v[140:143], v22 offset0:192 offset1:224
    ds_read2_b64 v[144:147], v47 offset0:0 offset1:32
    ds_read2_b64 v[148:151], v47 offset0:64 offset1:96
    ds_read2_b64 v[152:155], v47 offset0:128 offset1:160
    ds_read_b64 v[156:157], v22 offset:3584
    s_mov_b32 s62, 1
L_ret2:
    s_setpc_b64 s[60:61]
L_mf6:
    s_waitcnt lgkmcnt(0)
    v_mfma_f32_16x16x32_bf16 v[32:35], v[64:67], v[128:131], 0
    v_mfma_f32_16x16x32_bf16 v[36:39], v[68:71], v[128:131], 0
    v_mfma_f32_16x16x32_bf16 v[32:35], v[72:75], v[132:135], v[32:35]
    v_mfma_f32_16x16x32_bf16 v[36:39], v[76:79], v[132:135], v[36:39]
    v_mfma_f32_16x16x32_bf16 v[32:35], v[80:83], v[136:139], v[32:35]
    v_mfma_f32_16x16x32_bf16 v[36:39], v[84:87], v[136:139], v[36:39]
    v_mfma_f32_16x16x32_bf16 v[32:35], v[88:91], v[140:143], v[32:35]
    v_mfma_f32_16x16x32_bf16 v[36:39], v[92:95], v[140:143], v[36:39]
    v_mfma_f32_16x16x32_bf16 v[32:35], v[96:99], v[144:147], v[32:35]
    v_mfma_f32_16x16x32_bf16 v[36:39], v[100:103], v[144:147], v[36:39]
    v_mfma_f32_16x16x32_bf16 v[32:35], v[104:107], v[148:151], v[32:35]
    v_mfma_f32_16x16x32_bf16 v[36:39], v[108:111], v[148:151], v[36:39]
    s_mov_b32 s62, 2
    s_setpc_b64 s[60:61]
L_hpart:
    ds_read_b32 v48, v13 offset:16
L_hg:
    s_waitcnt vmcnt(0)
    v_xor_b32 v1, s28, v24
    v_xor_b32 v2, s28, v28
    v_bitop3_b32 v1, v25, s29, v1 bitop3:0xbe
    v_bitop3_b32 v2, v29, s29, v2 bitop3:0xbe
    v_bitop3_b32 v1, v26, s30, v1 bitop3:0xbe
    v_bitop3_b32 v2, v30, s30, v2 bitop3:0xbe
    v_bitop3_b32 v1, v27, s31, v1 bitop3:0xbe
    v_bitop3_b32 v2, v31, s31, v2 bitop3:0xbe
    v_bitop3_b32 v1, v1, v2, s59 bitop3:0x54
    v_cmp_ne_u32 vcc, 0, v1
    s_cbranch_vccz L_hg_ok
    s_sub_u32 s46, s46, 1
    s_cbranch_scc1 L_end
    s_sleep 4
    buffer_load_dwordx4 v[24:27], v46, s[4:7], 0 offen sc1
    buffer_load_dwordx4 v[28:31], v46, s[4:7], 0 offen offset:3584 sc1
    s_branch L_hg
L_hg_ok:
    v_mov_b32 v1, 1
    s_mov_b64 exec, 1
    ds_add_u32 v16, v1 offset:36
    s_mov_b64 exec, -1
    v_permlane32_swap_b32 v24, v26
    v_permlane32_swap_b32 v25, v27
    v_permlane32_swap_b32 v28, v30
    v_permlane32_swap_b32 v29, v31
    v_and_b32_sdwa v32, v24, s38 dst_sel:WORD_1 dst_unused:UNUSED_PAD src0_sel:WORD_0 src1_sel:DWORD
    v_and_b32 v33, s39, v24
    v_and_b32_sdwa v34, v25, s38 dst_sel:WORD_1 dst_unused:UNUSED_PAD src0_sel:WORD_0 src1_sel:DWORD
    v_and_b32 v35, s39, v25
    v_and_b32_sdwa v4, v26, s38 dst_sel:WORD_1 dst_unused:UNUSED_PAD src0_sel:WORD_0 src1_sel:DWORD
    v_and_b32 v5, s39, v26
    v_and_b32_sdwa v6, v27, s38 dst_sel:WORD_1 dst_unused:UNUSED_PAD src0_sel:WORD_0 src1_sel:DWORD
    v_and_b32 v7, s39, v27
    v_and_b32_sdwa v36, v28, s38 dst_sel:WORD_1 dst_unused:UNUSED_PAD src0_sel:WORD_0 src1_sel:DWORD
    v_and_b32 v37, s39, v28
    v_and_b32_sdwa v38, v29, s38 dst_sel:WORD_1 dst_unused:UNUSED_PAD src0_sel:WORD_0 src1_sel:DWORD
    v_and_b32 v39, s39, v29
    v_and_b32_sdwa v40, v30, s38 dst_sel:WORD_1 dst_unused:UNUSED_PAD src0_sel:WORD_0 src1_sel:DWORD
    v_and_b32 v41, s39, v30
    v_and_b32_sdwa v42, v31, s38 dst_sel:WORD_1 dst_unused:UNUSED_PAD src0_sel:WORD_0 src1_sel:DWORD
    v_and_b32 v43, s39, v31
    v_pk_add_f32 v[32:33], v[32:33], v[4:5]
    v_pk_add_f32 v[34:35], v[34:35], v[6:7]
    v_pk_add_f32 v[36:37], v[36:37], v[40:41]
    v_pk_add_f32 v[38:39], v[38:39], v[42:43]
    v_pk_mul_f32 v[32:33], v[32:33], s[44:45]
    v_pk_mul_f32 v[34:35], v[34:35], s[44:45]
    s_waitcnt lgkmcnt(0)
    v_pk_mul_f32 v[36:37], v[36:37], v[48:49] op_sel_hi:[1,0]
    v_pk_mul_f32 v[38:39], v[38:39], v[48:49] op_sel_hi:[1,0]
    v_max_f32 v32, 0, v32
    v_max_f32 v33, 0, v33
    v_max_f32 v34, 0, v34
    v_max_f32 v35, 0, v35
    v_pk_mul_f32 v[32:33], v[32:33], v[36:37]
    v_pk_mul_f32 v[34:35], v[34:35], v[38:39]
    s_mov_b32 s63, 2
    v_cvt_pk_bf16_f32 v6, v32, v33
    v_cvt_pk_bf16_f32 v7, v34, v35
    ds_write_b64 v12, v[6:7]
    s_mov_b64 exec, 1
    ds_add_u32 v16, v1 offset:4
    s_mov_b64 exec, -1
    s_setpc_b64 s[60:61]
L_cons:
    s_mov_b64 s[4:5], s[40:41]
    s_mov_b32 s6, 1589248
    s_mov_b32 s7, 0x20000
    s_load_dword s47, s[40:41], 268288
    s_lshr_b32 s8, s2, 2
    s_xor_b32 s8, s8, s2
    s_and_b32 s8, s8, 4
    s_mul_i32 s8, s8, 5
    s_xor_b32 s8, s8, s2
    s_cmpk_ge_u32 s2, 224
    s_cselect_b32 s97, s8, s2
    s_lshr_b32 s3, s3, 6
    v_and_b32 v0, 63, v0
    s_mov_b32 s46, 400000
    s_and_b32 s54, s2, 31
    s_lshr_b32 s55, s2, 5
    v_and_b32 v17, 15, v0
    v_lshrrev_b32 v18, 4, v0
    v_and_b32 v19, 7, v0
    s_sub_u32 s56, s97, 240
    s_cmp_ge_u32 s56, 8
    s_cbranch_scc1 L_c_nog
    s_cmp_lg_u32 s3, 3
    s_cbranch_scc1 L_c_nog
    s_mov_b64 s[8:9], s[16:17]
    s_lshl_b32 s56, s56, 11
    v_lshlrev_b32 v44, 5, v0
    buffer_load_dwordx4 v[48:51], v44, s[8:11], s56 offen
    buffer_load_dwordx4 v[52:55], v44, s[8:11], s56 offen offset:16
    s_mov_b64 s[8:9], s[34:35]
    s_movk_i32 s10, 2048
    buffer_load_dwordx4 v[56:59], v44, s[8:11], 0 offen
    buffer_load_dwordx4 v[60:63], v44, s[8:11], 0 offen offset:16
L_c_nog:
    s_mov_b32 s26, 0xff00ff00
    s_mov_b32 s27, 0xff00ff00
    s_mov_b32 s24, 0x20000000
    s_mov_b32 s25, 0x20000000
    s_mov_b32 s44, 0x5f000000
    s_mov_b32 s45, 0x5f000000
    s_mov_b32 s38, 0xbfff
    s_mov_b32 s39, 0xbfff0000
    s_mov_b32 s59, 0xbfffbfff
    v_bfe_u32 v1, v0, 3, 1
    v_lshlrev_b32 v1, 5, v1
    v_lshl_add_u32 v7, v18, 3, v1
    s_cmpk_ge_u32 s2, 128
    s_cbranch_scc1 L_c_addrG
    s_and_b32 s56, s54, 3
    s_lshl_b32 s58, s56, 16
    s_lshl_b32 s57, s55, 11
    s_add_u32 s58, s58, s57
    s_lshl_b32 s57, s3, 9
    s_add_u32 s58, s58, s57
    s_lshr_b32 s57, s54, 2
    s_lshl_b32 s57, s57, 6
    s_add_u32 s58, s58, s57
    s_add_u32 s58, s58, 786432
    v_and_b32 v1, 24, v19
    v_and_b32 v2, 3, v19
    v_lshl_add_u32 v1, v2, 1, v1
    v_bfe_u32 v2, v19, 2, 1
    v_add_lshl_u32 v1, v1, v2, 13
    v_add3_u32 v13, s58, v1, v7
    s_lshl_b32 s58, s56, 11
    s_lshl_b32 s57, s57, 2
    s_add_u32 s58, s58, s57
    s_lshl_b32 s57, s55, 6
    s_add_u32 s58, s58, s57
    s_add_u32 s58, s58, 1572864
    s_lshl_b32 s42, s56, 3
    s_lshl_b32 s96, s55, 8
    s_branch L_c_addr_done
L_c_addrG:
    s_and_b32 s56, s2, 1
    s_mul_i32 s58, s56, 3584
    s_bfe_u32 s56, s2, 0x10001
    s_mul_i32 s56, s56, 1792
    s_add_u32 s58, s58, s56
    s_add_u32 s58, s58, 524288
    s_sub_u32 s56, s97, 176
    s_lshr_b32 s57, s56, 2
    s_and_b32 s57, s57, 12
    s_lshr_b32 s57, 0x3201, s57
    s_and_b32 s57, s57, 3
    s_and_b32 s56, s56, 12
    s_add_u32 s57, s57, s56
    s_add_u32 s57, s57, 12
    s_bfe_u32 s56, s97, 0x50002
    s_xor_b32 s56, s56, 1
    s_cmp_lt_u32 s56, 12
    s_cselect_b32 s56, s56, s57
    s_mul_i32 s42, s56, 74904
    s_lshr_b32 s42, s42, 16
    s_movk_i32 s96, 1024
    s_lshl2_add_u32 s56, s56, s3
    s_lshl_b32 s56, s56, 1
    v_bfe_u32 v1, v0, 3, 1
    v_add_u32 v1, s56, v1
    v_mul_u32_u24 v3, 9363, v1
    v_lshrrev_b32 v3, 16, v3
    v_mul_u32_u24 v4, 7, v3
    v_sub_u32 v1, v1, v4
    v_and_b32 v4, 24, v3
    v_and_b32 v2, 3, v3
    v_lshl_add_u32 v4, v2, 1, v4
    v_bfe_u32 v2, v3, 2, 1
    v_add_lshl_u32 v4, v4, v2, 13
    v_lshl_add_u32 v4, v1, 8, v4
    v_lshl_add_u32 v4, v19, 5, v4
    v_lshl_add_u32 v4, v18, 3, v4
    v_add_u32 v13, s58, v4
    s_sub_u32 s58, s97, 240
    s_lshl_b32 s58, s58, 6
    s_add_u32 s58, s58, 1581056
L_c_addr_done:
    s_add_u32 s96, s96, 262144
    v_lshrrev_b32 v1, 1, v0
    v_add_u32 v1, s42, v1
    v_and_b32 v131, 24, v1
    v_and_b32 v2, 3, v1
    v_lshl_add_u32 v131, v2, 1, v131
    v_bfe_u32 v2, v1, 2, 1
    v_add_lshl_u32 v131, v131, v2, 13
    v_and_b32 v1, 1, v0
    v_lshl_add_u32 v131, v1, 7, v131
    v_lshlrev_b32 v1, 3, v19
    v_add_u32 v14, s58, v1
    v_mov_b32 v16, 154112
    v_lshrrev_b32 v1, 2, v0
    v_and_b32 v5, 7, v1
    v_lshlrev_b32 v5, 1, v5
    v_bfe_u32 v6, v0, 1, 1
    s_lshl_b32 s42, s3, 2
    v_add_u32 v6, s42, v6
    v_xor_b32 v6, v6, v5
    v_lshlrev_b32 v6, 4, v6
    v_lshl_add_u32 v6, v1, 8, v6
    v_and_b32 v5, 1, v0
    v_lshl_add_u32 v10, v5, 3, v6
    v_lshrrev_b32 v1, 5, v0
    v_lshlrev_b32 v1, 7, v1
    v_lshl_add_u32 v1, v19, 4, v1
    v_bfe_u32 v5, v0, 4, 1
    v_lshl_add_u32 v11, v5, 3, v1
    s_bfe_u32 s56, s51, 0x20004
    s_lshl_b32 s56, s56, 13
    s_and_b32 s57, s51, 1
    s_lshl_b32 s57, s57, 12
    s_add_u32 s56, s56, s57
    s_and_b32 s57, s3, 1
    s_lshl_b32 s57, s57, 11
    s_add_u32 s56, s56, s57
    s_and_b32 s57, s2, 3
    s_lshl_b32 s57, s57, 9
    s_add_u32 s56, s56, s57
    s_bfe_u32 s57, s51, 0x30001
    s_lshl_b32 s57, s57, 6
    s_add_u32 s56, s56, s57
    v_lshl_add_u32 v1, v19, 15, v7
    v_add_u32 v12, s56, v1
    v_lshrrev_b32 v8, 5, v0
    v_bfe_u32 v3, v0, 2, 3
    v_bfe_u32 v4, v0, 1, 1
    v_and_b32 v5, 1, v0
    v_lshlrev_b32 v6, 4, v3
    v_lshl_add_u32 v6, v5, 7, v6
    v_lshl_add_u32 v6, v8, 3, v6
    s_lshl_b32 s57, s3, 1
    v_add_u32 v7, s57, v4
    v_lshl_add_u32 v1, v7, 8, v6
    v_add_u32 v129, 149248, v1
    v_lshlrev_b32 v2, 5, v3
    v_add_u32 v130, 153856, v2
    s_and_b32 s56, s54, 24
    s_and_b32 s57, s54, 3
    s_lshl1_add_u32 s56, s57, s56
    s_bfe_u32 s57, s54, 0x10002
    s_add_u32 s56, s56, s57
    s_lshl_b32 s56, s56, 13
    s_lshl_b32 s57, s3, 9
    s_add_u32 s56, s56, s57
    s_add_u32 s56, s56, 786432
    v_and_b32 v1, 31, v0
    v_lshlrev_b32 v1, 4, v1
    v_lshl_add_u32 v1, v8, 12, v1
    v_add_u32 v128, s56, v1
    s_waitcnt lgkmcnt(0)
    s_add_u32 s47, s47, 1
    v_mov_b32 v2, 1
    v_mov_b32 v3, s47
    ds_write_b64 v16, v[2:3] offset:48
    s_add_u32 s56, s47, 0
    s_and_b32 s57, s56, 1
    s_lshl_b32 s57, s57, 14
    s_and_b32 s56, s56, 2
    s_lshl_b32 s56, s56, 29
    s_or_b32 s28, s56, s57
    s_add_u32 s56, s47, 1
    s_and_b32 s57, s56, 1
    s_lshl_b32 s57, s57, 14
    s_and_b32 s56, s56, 2
    s_lshl_b32 s56, s56, 29
    s_or_b32 s29, s56, s57
    s_add_u32 s56, s47, 2
    s_and_b32 s57, s56, 1
    s_lshl_b32 s57, s57, 14
    s_and_b32 s56, s56, 2
    s_lshl_b32 s56, s56, 29
    s_or_b32 s30, s56, s57
    s_add_u32 s56, s47, 3
    s_and_b32 s57, s56, 1
    s_lshl_b32 s57, s57, 14
    s_and_b32 s56, s56, 2
    s_lshl_b32 s56, s56, 29
    s_or_b32 s31, s56, s57
    v_and_b32 v5, 16, v0
    v_cmp_ne_u32 vcc, 0, v5
    v_mov_b32 v1, s28
    v_mov_b32 v2, s30
    v_cndmask_b32 v132, v1, v2, vcc
    v_mov_b32 v1, s29
    v_mov_b32 v2, s31
    v_cndmask_b32 v133, v1, v2, vcc
    v_mov_b32 v32, 0
    v_mov_b32 v33, 0
    v_mov_b32 v34, 0
    v_mov_b32 v35, 0
    v_mov_b32 v36, 0
    v_mov_b32 v37, 0
    v_mov_b32 v38, 0
    v_mov_b32 v39, 0
    s_lshr_b32 s57, s3, 1
    s_lshl_b32 s57, s57, 11
    s_add_u32 s57, s57, 131072
    v_add_u32 v22, s57, v11
    s_and_b32 s57, s3, 1
    v_lshl_add_u32 v47, s57, 2, v16
    s_lshl_b32 s57, s57, 10
    s_add_u32 s57, s57, 143360
    v_lshlrev_b32 v9, 4, v0
    v_add_u32 v9, s57, v9
    v_mov_b32 v20, v10
    v_xor_b32 v21, 32, v10
    s_mov_b32 s48, 64
    s_waitcnt vmcnt(0)
    v_mov_b32 v1, 1
    s_mov_b64 exec, 1
    ds_add_u32 v16, v1 offset:44
    s_mov_b64 exec, -1
Lsy_30:
    ds_read_b32 v1, v16 offset:44
    s_waitcnt lgkmcnt(0)
    v_readfirstlane_b32 s56, v1
    s_cmp_ge_u32 s56, 4
    s_cbranch_scc1 Lsy_30_ok
    s_sub_u32 s46, s46, 1
    s_cbranch_scc1 L_end
    s_branch Lsy_30
Lsy_30_ok:
    s_mov_b32 s49, 0
    s_add_u32 s50, s49, 8
    s_call_b64 s[52:53], L_blk
    v_mov_b32 v1, 1
    s_mov_b64 exec, 1
    ds_add_u32 v16, v1 offset:16
    s_mov_b64 exec, -1
    s_mov_b32 s48, 0
    s_nop 1
    v_cndmask_b32 v40, v32, v36, s[26:27]
    v_cndmask_b32 v41, v33, v37, s[26:27]
    v_cndmask_b32 v42, v34, v38, s[26:27]
    v_cndmask_b32 v43, v35, v39, s[26:27]
    s_cmp_lt_u32 s3, 2
    s_cbranch_scc1 L_q_lo
    ds_write_b128 v9, v[40:43]
    v_mov_b32 v1, 1
    s_mov_b64 exec, 1
    ds_add_u32 v47, v1 offset:56
    s_mov_b64 exec, -1
    s_branch L_q_done
L_q_lo:
Lsp_31:
    ds_read_b32 v1, v47 offset:56
    ds_read_b128 v[4:7], v9
    s_waitcnt lgkmcnt(1)
    v_readfirstlane_b32 s56, v1
    s_cmp_ge_u32 s56, 1
    s_cbranch_scc1 Lsp_31_ok
    s_sub_u32 s46, s46, 1
    s_cbranch_scc1 L_end
    s_branch Lsp_31
Lsp_31_ok:
    s_waitcnt lgkmcnt(0)
    v_pk_add_f32 v[40:41], v[40:41], v[4:5]
    v_pk_add_f32 v[42:43], v[42:43], v[6:7]
    v_pk_mul_f32 v[40:41], v[40:41], s[24:25]
    v_pk_mul_f32 v[42:43], v[42:43], s[24:25]
    v_cvt_pk_bf16_f32 v40, v40, v41
    v_cvt_pk_bf16_f32 v41, v42, v43
    v_and_or_b32 v40, v40, s59, v132
    v_and_or_b32 v41, v41, s59, v133
    buffer_store_dwordx2 v[40:41], v12, s[4:7], 0 offen sc1
L_q_done:
    s_cmpk_ge_u32 s2, 128
    s_cbranch_scc1 L_c_notA
    s_lshl_b32 s56, s54, 13
    s_lshl_b32 s57, s3, 11
    s_add_u32 s56, s56, s57
    v_and_b32 v9, 31, v0
    v_lshlrev_b32 v9, 4, v9
    v_lshrrev_b32 v8, 5, v0
    v_lshl_add_u32 v9, v8, 10, v9
    v_add_u32 v9, s56, v9
    v_xor_b32 v1, v18, v17
    v_lshlrev_b32 v1, 4, v1
    v_lshl_add_u32 v1, v17, 8, v1
    s_lshl_b32 s57, s3, 14
    s_add_u32 s57, s57, 32768
    v_add_u32 v44, s57, v1
    v_xor_b32 v45, 64, v44
    v_xor_b32 v46, 0x80, v44
    v_xor_b32 v47, 0xc0, v44
    s_mov_b32 s49, 16
    s_call_b64 s[52:53], L_pw
    buffer_load_dwordx4 v[48:51], v9, s[4:7], 0 offen sc1
    buffer_load_dwordx4 v[52:55], v9, s[4:7], 0 offen offset:512 sc1
    ds_read_b128 v[64:67], v44 offset:0
    ds_read_b128 v[68:71], v45 offset:0
    ds_read_b128 v[72:75], v46 offset:0
    ds_read_b128 v[76:79], v47 offset:0
    ds_read_b128 v[80:83], v44 offset:4096
    ds_read_b128 v[84:87], v45 offset:4096
    ds_read_b128 v[88:91], v46 offset:4096
    ds_read_b128 v[92:95], v47 offset:4096
    ds_read_b128 v[96:99], v44 offset:8192
    ds_read_b128 v[100:103], v45 offset:8192
    ds_read_b128 v[104:107], v46 offset:8192
    ds_read_b128 v[108:111], v47 offset:8192
    s_waitcnt lgkmcnt(8)
    ds_read_b128 v[112:115], v44 offset:12288
    ds_read_b128 v[116:119], v45 offset:12288
    ds_read_b128 v[120:123], v46 offset:12288
    ds_read_b128 v[124:127], v47 offset:12288
    v_mov_b32 v1, 1
    s_mov_b64 exec, 1
    ds_add_u32 v16, v1 offset:20
    s_mov_b64 exec, -1
    v_and_b32 v1, 3, v0
    v_lshlrev_b32 v1, 7, v1
    v_bfe_u32 v3, v0, 2, 3
    v_lshl_add_u32 v1, v3, 4, v1
    v_lshl_add_u32 v1, v8, 3, v1
    s_lshl_b32 s57, s3, 9
    s_add_u32 s57, s57, 151552
    v_add_u32 v46, s57, v1
    v_lshlrev_b32 v45, 7, v18
    v_lshl_add_u32 v45, v19, 4, v45
    v_add_u32 v45, 151552, v45
L_qg:
    s_waitcnt vmcnt(0)
    v_xor_b32 v1, s28, v48
    v_xor_b32 v2, s28, v52
    v_bitop3_b32 v1, v49, s29, v1 bitop3:0xbe
    v_bitop3_b32 v2, v53, s29, v2 bitop3:0xbe
    v_bitop3_b32 v1, v50, s30, v1 bitop3:0xbe
    v_bitop3_b32 v2, v54, s30, v2 bitop3:0xbe
    v_bitop3_b32 v1, v51, s31, v1 bitop3:0xbe
    v_bitop3_b32 v2, v55, s31, v2 bitop3:0xbe
    v_bitop3_b32 v1, v1, v2, s59 bitop3:0x54
    s_nop 1
    v_or_b32_dpp v1, v1, v1 quad_perm:[1,0,3,2] row_mask:0xf bank_mask:0xf
    s_nop 1
    v_or_b32_dpp v1, v1, v1 quad_perm:[2,3,0,1] row_mask:0xf bank_mask:0xf
    v_cmpx_ne_u32 vcc, 0, v1
    s_cbranch_execz L_qg_ok
    s_sub_u32 s46, s46, 1
    s_cbranch_scc1 L_end
    buffer_load_dwordx4 v[48:51], v9, s[4:7], 0 offen sc1
    buffer_load_dwordx4 v[52:55], v9, s[4:7], 0 offen offset:512 sc1
    s_branch L_qg
L_qg_ok:
    s_mov_b64 exec, -1
    s_nop 2
    v_permlane32_swap_b32 v48, v50
    v_permlane32_swap_b32 v49, v51
    v_permlane32_swap_b32 v52, v54
    v_permlane32_swap_b32 v53, v55
    v_and_b32_sdwa v24, v48, s38 dst_sel:WORD_1 dst_unused:UNUSED_PAD src0_sel:WORD_0 src1_sel:DWORD
    v_and_b32 v25, s39, v48
    v_and_b32_sdwa v26, v49, s38 dst_sel:WORD_1 dst_unused:UNUSED_PAD src0_sel:WORD_0 src1_sel:DWORD
    v_and_b32 v27, s39, v49
    v_and_b32_sdwa v28, v50, s38 dst_sel:WORD_1 dst_unused:UNUSED_PAD src0_sel:WORD_0 src1_sel:DWORD
    v_and_b32 v29, s39, v50
    v_and_b32_sdwa v30, v51, s38 dst_sel:WORD_1 dst_unused:UNUSED_PAD src0_sel:WORD_0 src1_sel:DWORD
    v_and_b32 v31, s39, v51
    v_and_b32_sdwa v32, v52, s38 dst_sel:WORD_1 dst_unused:UNUSED_PAD src0_sel:WORD_0 src1_sel:DWORD
    v_and_b32 v33, s39, v52
    v_and_b32_sdwa v34, v53, s38 dst_sel:WORD_1 dst_unused:UNUSED_PAD src0_sel:WORD_0 src1_sel:DWORD
    v_and_b32 v35, s39, v53
    v_and_b32_sdwa v36, v54, s38 dst_sel:WORD_1 dst_unused:UNUSED_PAD src0_sel:WORD_0 src1_sel:DWORD
    v_and_b32 v37, s39, v54
    v_and_b32_sdwa v38, v55, s38 dst_sel:WORD_1 dst_unused:UNUSED_PAD src0_sel:WORD_0 src1_sel:DWORD
    v_and_b32 v39, s39, v55
    v_pk_add_f32 v[24:25], v[24:25], v[28:29]
    v_pk_add_f32 v[26:27], v[26:27], v[30:31]
    v_pk_add_f32 v[32:33], v[32:33], v[36:37]
    v_pk_add_f32 v[34:35], v[34:35], v[38:39]
    v_pk_add_f32 v[24:25], v[24:25], v[32:33]
    v_pk_add_f32 v[26:27], v[26:27], v[34:35]
    v_pk_mul_f32 v[24:25], v[24:25], s[44:45]
    v_pk_mul_f32 v[26:27], v[26:27], s[44:45]
    v_cvt_pk_bf16_f32 v24, v24, v25
    v_cvt_pk_bf16_f32 v25, v26, v27
    ds_write_b64 v46, v[24:25]
    v_mov_b32 v1, 1
    s_mov_b64 exec, 1
    ds_add_u32 v16, v1 offset:24
    s_mov_b64 exec, -1
Lsp_32:
    ds_read_b32 v1, v16 offset:24
    ds_read_b128 v[48:51], v45 offset:0
    ds_read_b128 v[52:55], v45 offset:512
    ds_read_b128 v[56:59], v45 offset:1024
    ds_read_b128 v[60:63], v45 offset:1536
    s_waitcnt lgkmcnt(4)
    v_readfirstlane_b32 s56, v1
    s_cmp_ge_u32 s56, 4
    s_cbranch_scc1 Lsp_32_ok
    s_sub_u32 s46, s46, 1
    s_cbranch_scc1 L_end
    s_branch Lsp_32
Lsp_32_ok:
    v_lshlrev_b32 v45, 4, v19
    v_add_u32 v45, 153600, v45
    s_lshl_b32 s57, s3, 2
    v_add_u32 v46, s57, v45
    s_waitcnt lgkmcnt(3)
    v_mfma_f32_16x16x32_bf16 v[24:27], v[64:67], v[48:51], 0
    v_mfma_f32_16x16x32_bf16 v[28:31], v[80:83], v[48:51], 0
    v_mfma_f32_16x16x32_bf16 v[32:35], v[96:99], v[48:51], 0
    v_mfma_f32_16x16x32_bf16 v[36:39], v[112:115], v[48:51], 0
    s_waitcnt lgkmcnt(2)
    v_mfma_f32_16x16x32_bf16 v[24:27], v[68:71], v[52:55], v[24:27]
    v_mfma_f32_16x16x32_bf16 v[28:31], v[84:87], v[52:55], v[28:31]
    v_mfma_f32_16x16x32_bf16 v[32:35], v[100:103], v[52:55], v[32:35]
    v_mfma_f32_16x16x32_bf16 v[36:39], v[116:119], v[52:55], v[36:39]
    s_waitcnt lgkmcnt(1)
    v_mfma_f32_16x16x32_bf16 v[24:27], v[72:75], v[56:59], v[24:27]
    v_mfma_f32_16x16x32_bf16 v[28:31], v[88:91], v[56:59], v[28:31]
    v_mfma_f32_16x16x32_bf16 v[32:35], v[104:107], v[56:59], v[32:35]
    v_mfma_f32_16x16x32_bf16 v[36:39], v[120:123], v[56:59], v[36:39]
    s_waitcnt lgkmcnt(0)
    v_mfma_f32_16x16x32_bf16 v[24:27], v[76:79], v[60:63], v[24:27]
    v_mfma_f32_16x16x32_bf16 v[28:31], v[92:95], v[60:63], v[28:31]
    v_mfma_f32_16x16x32_bf16 v[32:35], v[108:111], v[60:63], v[32:35]
    v_mfma_f32_16x16x32_bf16 v[36:39], v[124:127], v[60:63], v[36:39]
    s_nop 4
    v_max3_f32 v2, v24, v25, v26
    v_max3_f32 v2, v2, v27, v28
    v_max3_f32 v2, v2, v29, v30
    v_max3_f32 v2, v2, v31, v32
    v_max3_f32 v2, v2, v33, v34
    v_max3_f32 v2, v2, v35, v36
    v_max3_f32 v2, v2, v37, v38
    v_max_f32 v2, v2, v39
    v_mov_b32 v3, v2
    s_nop 1
    v_permlane16_swap_b32 v2, v3
    v_max_f32 v2, v2, v3
    v_mov_b32 v3, v2
    s_nop 1
    v_permlane32_swap_b32 v2, v3
    v_max_f32 v2, v2, v3
    ds_write_b32 v46, v2
    v_mov_b32 v1, 1
    s_mov_b64 exec, 1
    ds_add_u32 v16, v1 offset:28
    s_mov_b64 exec, -1
Lsp_33:
    ds_read_b32 v1, v16 offset:28
    ds_read_b128 v[4:7], v45
    s_waitcnt lgkmcnt(1)
    v_readfirstlane_b32 s56, v1
    s_cmp_ge_u32 s56, 4
    s_cbranch_scc1 Lsp_33_ok
    s_sub_u32 s46, s46, 1
    s_cbranch_scc1 L_end
    s_branch Lsp_33
Lsp_33_ok:
    s_mov_b32 s58, 1040356334
    s_lshl_b32 s57, s3, 10
    s_add_u32 s57, s57, 143360
    v_add_u32 v44, s57, v11
    s_waitcnt lgkmcnt(0)
    v_max3_f32 v2, v4, v5, v6
    v_max_f32 v2, v2, v7
    v_mul_f32 v47, s58, v2
    v_fma_f32 v24, v24, s58, -v47
    v_fma_f32 v25, v25, s58, -v47
    v_fma_f32 v26, v26, s58, -v47
    v_fma_f32 v27, v27, s58, -v47
    v_fma_f32 v28, v28, s58, -v47
    v_fma_f32 v29, v29, s58, -v47
    v_fma_f32 v30, v30, s58, -v47
    v_fma_f32 v31, v31, s58, -v47
    v_fma_f32 v32, v32, s58, -v47
    v_fma_f32 v33, v33, s58, -v47
    v_fma_f32 v34, v34, s58, -v47
    v_fma_f32 v35, v35, s58, -v47
    v_fma_f32 v36, v36, s58, -v47
    v_fma_f32 v37, v37, s58, -v47
    v_fma_f32 v38, v38, s58, -v47
    v_fma_f32 v39, v39, s58, -v47
    v_exp_f32 v24, v24
    v_exp_f32 v25, v25
    v_exp_f32 v26, v26
    v_exp_f32 v27, v27
    v_exp_f32 v28, v28
    v_exp_f32 v29, v29
    v_exp_f32 v30, v30
    v_exp_f32 v31, v31
    v_exp_f32 v32, v32
    v_exp_f32 v33, v33
    v_exp_f32 v34, v34
    v_exp_f32 v35, v35
    v_exp_f32 v36, v36
    v_exp_f32 v37, v37
    v_exp_f32 v38, v38
    v_exp_f32 v39, v39
    v_cvt_pk_bf16_f32 v48, v24, v25
    v_cvt_pk_bf16_f32 v49, v26, v27
    v_cvt_pk_bf16_f32 v50, v28, v29
    v_cvt_pk_bf16_f32 v51, v30, v31
    v_cvt_pk_bf16_f32 v52, v32, v33
    v_cvt_pk_bf16_f32 v53, v34, v35
    v_cvt_pk_bf16_f32 v54, v36, v37
    v_cvt_pk_bf16_f32 v55, v38, v39
    ds_write_b64 v44, v[48:49] offset:0
    ds_write_b64 v44, v[50:51] offset:256
    ds_write_b64 v44, v[52:53] offset:512
    ds_write_b64 v44, v[54:55] offset:768
    v_pk_add_f32 v[24:25], v[24:25], v[26:27]
    v_pk_add_f32 v[28:29], v[28:29], v[30:31]
    v_pk_add_f32 v[32:33], v[32:33], v[34:35]
    v_pk_add_f32 v[36:37], v[36:37], v[38:39]
    v_pk_add_f32 v[24:25], v[24:25], v[28:29]
    v_pk_add_f32 v[32:33], v[32:33], v[36:37]
    v_pk_add_f32 v[24:25], v[24:25], v[32:33]
    v_add_f32 v2, v24, v25
    v_mov_b32 v3, v2
    s_nop 1
    v_permlane16_swap_b32 v2, v3
    v_add_f32 v2, v2, v3
    v_mov_b32 v3, v2
    s_nop 1
    v_permlane32_swap_b32 v2, v3
    v_add_f32 v2, v2, v3
    ds_write_b32 v46, v2 offset:128
    v_mov_b32 v1, 1
    s_mov_b64 exec, 1
    ds_add_u32 v16, v1 offset:32
    s_mov_b64 exec, -1
    v_mov_b32 v32, 0
    v_mov_b32 v33, 0
    v_mov_b32 v34, 0
    v_mov_b32 v35, 0
    v_mov_b32 v36, 0
    v_mov_b32 v37, 0
    v_mov_b32 v38, 0
    v_mov_b32 v39, 0
Lsp_34:
    ds_read_b32 v1, v16 offset:32
    ds_read_b128 v[4:7], v45 offset:128
    s_waitcnt lgkmcnt(1)
    v_readfirstlane_b32 s56, v1
    s_cmp_ge_u32 s56, 4
    s_cbranch_scc1 Lsp_34_ok
    s_sub_u32 s46, s46, 1
    s_cbranch_scc1 L_end
    s_branch Lsp_34
Lsp_34_ok:
    s_waitcnt lgkmcnt(0)
    v_add_f32 v4, v4, v5
    v_add_f32 v6, v6, v7
    v_add_f32 v4, v4, v6
    v_rcp_f32 v46, v4
    v_log_f32 v5, v4
    s_cmp_lg_u32 s3, 0
    v_mul_f32 v46, s24, v46
    v_add_f32 v4, v47, v5
    s_cbranch_scc1 L_now
    v_mov_b32 v5, s47
    s_mov_b64 exec, 0xff
    buffer_store_dwordx2 v[4:5], v14, s[4:7], 0 offen sc1
    s_mov_b64 exec, -1
L_now:
    v_add_u32 v20, 98304, v10
    v_xor_b32 v21, 32, v20
    v_add_u32 v22, 143360, v11
    s_mov_b32 s49, 17
    s_add_u32 s50, s49, 8
    s_call_b64 s[52:53], L_blk0
    s_mov_b64 s[12:13], 65535
    s_branch L_c_last8
L_c_notA:
    s_cmpk_ge_u32 s97, 240
    s_cbranch_scc1 L_c_S
    v_mov_b32 v32, 0
    v_mov_b32 v33, 0
    v_mov_b32 v34, 0
    v_mov_b32 v35, 0
    v_mov_b32 v36, 0
    v_mov_b32 v37, 0
    v_mov_b32 v38, 0
    v_mov_b32 v39, 0
    v_add_u32 v20, 32768, v10
    v_xor_b32 v21, 32, v20
    v_add_u32 v22, 135168, v11
    s_mov_b32 s49, 1
    s_add_u32 s50, s49, 16
    s_call_b64 s[52:53], L_blk0
    v_mov_b32 v1, 1
    s_mov_b64 exec, 1
    ds_add_u32 v16, v1 offset:20
    s_mov_b64 exec, -1
    s_add_u32 s50, s49, 8
    s_call_b64 s[52:53], L_blk0
    s_mov_b64 s[12:13], 15
    v_mov_b32 v46, s24
L_c_last8:
    v_mov_b32 v9, 1
    v_mov_b32 v20, v10
    v_xor_b32 v21, 32, v20
    s_add_u32 s50, s49, 4
    s_call_b64 s[52:53], L_blk0
Lsd_35:
    ds_read_b64 v[2:3], v16 offset:64
    s_waitcnt lgkmcnt(0)
    v_readfirstlane_b32 s56, v2
    v_readfirstlane_b32 s57, v3
    s_cmp_lg_u32 s56, 0
    s_cbranch_scc1 Lsd_35_ok
    s_sub_u32 s46, s46, 1
    s_cbranch_scc1 L_end
    s_sleep 1
    s_branch Lsd_35
Lsd_35_ok:
    v_xor_b32 v13, s57, v13
    v_xor_b32 v131, s57, v131
    s_add_u32 s50, s49, 4
    s_call_b64 s[52:53], L_blk0
    s_nop 5
    v_cndmask_b32 v40, v32, v36, s[26:27]
    v_cndmask_b32 v41, v33, v37, s[26:27]
    v_cndmask_b32 v42, v34, v38, s[26:27]
    v_cndmask_b32 v43, v35, v39, s[26:27]
    v_pk_mul_f32 v[40:41], v[40:41], v[46:47] op_sel_hi:[1,0]
    v_pk_mul_f32 v[42:43], v[42:43], v[46:47] op_sel_hi:[1,0]
    v_cvt_pk_bf16_f32 v40, v40, v41
    v_cvt_pk_bf16_f32 v41, v42, v43
    v_and_or_b32 v40, v40, s59, v132
    v_and_or_b32 v41, v41, s59, v133
    buffer_store_dwordx2 v[40:41], v13, s[4:7], 0 offen sc1
    s_cmp_lg_u32 s3, 0
    s_cbranch_scc1 L_c_F
    s_mov_b64 exec, s[12:13]
    buffer_atomic_add v9, v131, s[4:7], s96 offen sc1
    s_mov_b64 exec, -1
    s_branch L_c_F
L_c_S:
    s_cmpk_ge_u32 s97, 248
    s_cbranch_scc1 L_c_F
    s_cmp_lg_u32 s3, 3
    s_cbranch_scc1 L_c_F
    s_mov_b32 s57, 0xffff0000
    v_mov_b32 v2, 0
    v_lshlrev_b32 v4, 16, v48
    v_lshlrev_b32 v5, 16, v56
    v_and_b32 v6, s57, v48
    v_and_b32 v7, s57, v56
    v_mul_f32 v4, v4, v5
    v_mul_f32 v6, v6, v7
    v_cvt_pk_bf16_f32 v4, v4, v6
    v_lshlrev_b32 v5, 16, v4
    v_and_b32 v6, s57, v4
    v_add_f32 v2, v2, v5
    v_add_f32 v2, v2, v6
    v_lshlrev_b32 v4, 16, v49
    v_lshlrev_b32 v5, 16, v57
    v_and_b32 v6, s57, v49
    v_and_b32 v7, s57, v57
    v_mul_f32 v4, v4, v5
    v_mul_f32 v6, v6, v7
    v_cvt_pk_bf16_f32 v4, v4, v6
    v_lshlrev_b32 v5, 16, v4
    v_and_b32 v6, s57, v4
    v_add_f32 v2, v2, v5
    v_add_f32 v2, v2, v6
    v_lshlrev_b32 v4, 16, v50
    v_lshlrev_b32 v5, 16, v58
    v_and_b32 v6, s57, v50
    v_and_b32 v7, s57, v58
    v_mul_f32 v4, v4, v5
    v_mul_f32 v6, v6, v7
    v_cvt_pk_bf16_f32 v4, v4, v6
    v_lshlrev_b32 v5, 16, v4
    v_and_b32 v6, s57, v4
    v_add_f32 v2, v2, v5
    v_add_f32 v2, v2, v6
    v_lshlrev_b32 v4, 16, v51
    v_lshlrev_b32 v5, 16, v59
    v_and_b32 v6, s57, v51
    v_and_b32 v7, s57, v59
    v_mul_f32 v4, v4, v5
    v_mul_f32 v6, v6, v7
    v_cvt_pk_bf16_f32 v4, v4, v6
    v_lshlrev_b32 v5, 16, v4
    v_and_b32 v6, s57, v4
    v_add_f32 v2, v2, v5
    v_add_f32 v2, v2, v6
    v_lshlrev_b32 v4, 16, v52
    v_lshlrev_b32 v5, 16, v60
    v_and_b32 v6, s57, v52
    v_and_b32 v7, s57, v60
    v_mul_f32 v4, v4, v5
    v_mul_f32 v6, v6, v7
    v_cvt_pk_bf16_f32 v4, v4, v6
    v_lshlrev_b32 v5, 16, v4
    v_and_b32 v6, s57, v4
    v_add_f32 v2, v2, v5
    v_add_f32 v2, v2, v6
    v_lshlrev_b32 v4, 16, v53
    v_lshlrev_b32 v5, 16, v61
    v_and_b32 v6, s57, v53
    v_and_b32 v7, s57, v61
    v_mul_f32 v4, v4, v5
    v_mul_f32 v6, v6, v7
    v_cvt_pk_bf16_f32 v4, v4, v6
    v_lshlrev_b32 v5, 16, v4
    v_and_b32 v6, s57, v4
    v_add_f32 v2, v2, v5
    v_add_f32 v2, v2, v6
    v_lshlrev_b32 v4, 16, v54
    v_lshlrev_b32 v5, 16, v62
    v_and_b32 v6, s57, v54
    v_and_b32 v7, s57, v62
    v_mul_f32 v4, v4, v5
    v_mul_f32 v6, v6, v7
    v_cvt_pk_bf16_f32 v4, v4, v6
    v_lshlrev_b32 v5, 16, v4
    v_and_b32 v6, s57, v4
    v_add_f32 v2, v2, v5
    v_add_f32 v2, v2, v6
    v_lshlrev_b32 v4, 16, v55
    v_lshlrev_b32 v5, 16, v63
    v_and_b32 v6, s57, v55
    v_and_b32 v7, s57, v63
    v_mul_f32 v4, v4, v5
    v_mul_f32 v6, v6, v7
    v_cvt_pk_bf16_f32 v4, v4, v6
    v_lshlrev_b32 v5, 16, v4
    v_and_b32 v6, s57, v4
    v_add_f32 v2, v2, v5
    v_add_f32 v2, v2, v6
    s_nop 1
    v_add_f32_dpp v2, v2, v2 row_ror:1 row_mask:0xf bank_mask:0xf
    s_nop 1
    v_add_f32_dpp v2, v2, v2 row_ror:2 row_mask:0xf bank_mask:0xf
    s_nop 1
    v_add_f32_dpp v2, v2, v2 row_ror:4 row_mask:0xf bank_mask:0xf
    s_nop 1
    v_add_f32_dpp v2, v2, v2 row_ror:8 row_mask:0xf bank_mask:0xf
    v_mov_b32 v3, v2
    s_nop 1
    v_permlane16_swap_b32 v2, v3
    v_add_f32 v2, v2, v3
    v_mov_b32 v3, v2
    s_nop 1
    v_permlane32_swap_b32 v2, v3
    v_add_f32 v2, v2, v3
    v_cvt_pk_bf16_f32 v2, v2, v2
    v_lshlrev_b32 v2, 16, v2
    v_mul_f32 v2, 3216550459, v2
    v_exp_f32 v2, v2
    s_nop 0
    v_add_f32 v2, 1.0, v2
    v_rcp_f32 v2, v2
    s_nop 0
    v_cvt_pk_bf16_f32 v2, v2, v2
    v_lshlrev_b32 v4, 16, v2
    v_mov_b32 v5, s47
    s_mov_b64 exec, 0xff
    buffer_store_dwordx2 v[4:5], v14, s[4:7], 0 offen sc1
    s_mov_b64 exec, -1
L_c_F:
Lsd_36:
    ds_read_b64 v[2:3], v16 offset:64
    s_waitcnt lgkmcnt(0)
    v_readfirstlane_b32 s56, v2
    v_readfirstlane_b32 s57, v3
    s_cmp_lg_u32 s56, 0
    s_cbranch_scc1 Lsd_36_ok
    s_sub_u32 s46, s46, 1
    s_cbranch_scc1 L_end
    s_sleep 1
    s_branch Lsd_36
Lsd_36_ok:
    v_xor_b32 v128, s57, v128
Lsy_37:
    ds_read_b32 v1, v16 offset:12
    s_waitcnt lgkmcnt(0)
    v_readfirstlane_b32 s56, v1
    s_cmp_ge_u32 s56, 1
    s_cbranch_scc1 Lsy_37_ok
    s_sub_u32 s46, s46, 1
    s_cbranch_scc1 L_end
    s_branch Lsy_37
Lsy_37_ok:
    s_setprio 2
    buffer_load_dwordx4 v[48:51], v128, s[4:7], 0 offen sc1
    buffer_load_dwordx4 v[52:55], v128, s[4:7], 0 offen offset:2048 sc1
L_fg:
    s_waitcnt vmcnt(0)
    v_xor_b32 v1, s28, v48
    v_xor_b32 v2, s28, v52
    v_bitop3_b32 v1, v49, s29, v1 bitop3:0xbe
    v_bitop3_b32 v2, v53, s29, v2 bitop3:0xbe
    v_bitop3_b32 v1, v50, s30, v1 bitop3:0xbe
    v_bitop3_b32 v2, v54, s30, v2 bitop3:0xbe
    v_bitop3_b32 v1, v51, s31, v1 bitop3:0xbe
    v_bitop3_b32 v2, v55, s31, v2 bitop3:0xbe
    v_bitop3_b32 v1, v1, v2, s59 bitop3:0x54
    s_nop 1
    v_or_b32_dpp v1, v1, v1 quad_perm:[1,0,3,2] row_mask:0xf bank_mask:0xf
    s_nop 1
    v_or_b32_dpp v1, v1, v1 quad_perm:[2,3,0,1] row_mask:0xf bank_mask:0xf
    v_cmpx_ne_u32 vcc, 0, v1
    s_cbranch_execz L_fg_ok
    s_sub_u32 s46, s46, 1
    s_cbranch_scc1 L_end
    s_sleep 4
    buffer_load_dwordx4 v[48:51], v128, s[4:7], 0 offen sc1
    buffer_load_dwordx4 v[52:55], v128, s[4:7], 0 offen offset:2048 sc1
    s_branch L_fg
L_fg_ok:
    s_mov_b64 exec, -1
    ds_read_b32 v3, v16 offset:40
    ds_read_b128 v[56:59], v130
    v_mov_b32 v1, 1
    s_mov_b64 exec, 1
    ds_add_u32 v16, v1 offset:36
    s_mov_b64 exec, -1
    v_permlane32_swap_b32 v48, v50
    v_permlane32_swap_b32 v49, v51
    v_permlane32_swap_b32 v52, v54
    v_permlane32_swap_b32 v53, v55
    v_and_b32_sdwa v24, v48, s38 dst_sel:WORD_1 dst_unused:UNUSED_PAD src0_sel:WORD_0 src1_sel:DWORD
    v_and_b32 v25, s39, v48
    v_and_b32_sdwa v26, v49, s38 dst_sel:WORD_1 dst_unused:UNUSED_PAD src0_sel:WORD_0 src1_sel:DWORD
    v_and_b32 v27, s39, v49
    v_and_b32_sdwa v28, v52, s38 dst_sel:WORD_1 dst_unused:UNUSED_PAD src0_sel:WORD_0 src1_sel:DWORD
    v_and_b32 v29, s39, v52
    v_and_b32_sdwa v30, v53, s38 dst_sel:WORD_1 dst_unused:UNUSED_PAD src0_sel:WORD_0 src1_sel:DWORD
    v_and_b32 v31, s39, v53
    v_and_b32_sdwa v32, v50, s38 dst_sel:WORD_1 dst_unused:UNUSED_PAD src0_sel:WORD_0 src1_sel:DWORD
    v_and_b32 v33, s39, v50
    v_and_b32_sdwa v34, v51, s38 dst_sel:WORD_1 dst_unused:UNUSED_PAD src0_sel:WORD_0 src1_sel:DWORD
    v_and_b32 v35, s39, v51
    v_and_b32_sdwa v36, v54, s38 dst_sel:WORD_1 dst_unused:UNUSED_PAD src0_sel:WORD_0 src1_sel:DWORD
    v_and_b32 v37, s39, v54
    v_and_b32_sdwa v38, v55, s38 dst_sel:WORD_1 dst_unused:UNUSED_PAD src0_sel:WORD_0 src1_sel:DWORD
    v_and_b32 v39, s39, v55
    s_waitcnt lgkmcnt(0)
    v_readfirstlane_b32 s56, v3
    s_cmp_lg_u32 s56, 0
    s_cbranch_scc1 L_wr_ok
Lsp_38:
    ds_read_b32 v1, v16 offset:40
    ds_read_b128 v[56:59], v130
    s_waitcnt lgkmcnt(1)
    v_readfirstlane_b32 s56, v1
    s_cmp_ge_u32 s56, 1
    s_cbranch_scc1 Lsp_38_ok
    s_sub_u32 s46, s46, 1
    s_cbranch_scc1 L_end
    s_branch Lsp_38
Lsp_38_ok:
    s_waitcnt lgkmcnt(0)
L_wr_ok:
    v_pk_mul_f32 v[24:25], v[24:25], v[56:57] op_sel_hi:[1,0]
    v_pk_mul_f32 v[26:27], v[26:27], v[56:57] op_sel_hi:[1,0]
    v_pk_mul_f32 v[32:33], v[32:33], v[58:59] op_sel_hi:[1,0]
    v_pk_mul_f32 v[34:35], v[34:35], v[58:59] op_sel_hi:[1,0]
    v_pk_fma_f32 v[24:25], v[28:29], v[56:57], v[24:25] op_sel:[0,1,0] op_sel_hi:[1,1,1]
    v_pk_fma_f32 v[26:27], v[30:31], v[56:57], v[26:27] op_sel:[0,1,0] op_sel_hi:[1,1,1]
    v_pk_fma_f32 v[32:33], v[36:37], v[58:59], v[32:33] op_sel:[0,1,0] op_sel_hi:[1,1,1]
    v_pk_fma_f32 v[34:35], v[38:39], v[58:59], v[34:35] op_sel:[0,1,0] op_sel_hi:[1,1,1]
    v_pk_add_f32 v[24:25], v[24:25], v[32:33]
    v_pk_add_f32 v[26:27], v[26:27], v[34:35]
    v_mov_b32 v1, 1
    v_cvt_pk_bf16_f32 v4, v24, v25
    v_cvt_pk_bf16_f32 v5, v26, v27
    ds_write_b64 v129, v[4:5]
    s_mov_b64 exec, 1
    ds_add_u32 v16, v1 offset:4
L_end:
    s_endpgm
L_pw:
    ds_read_b32 v1, v16 offset:0
    s_waitcnt lgkmcnt(0)
    v_readfirstlane_b32 s48, v1
    s_cmp_ge_i32 s48, s49
    s_cbranch_scc1 L_ret
    s_sub_u32 s46, s46, 1
    s_cbranch_scc1 L_end
    s_sleep 0
    s_branch L_pw
L_blk0:
    ds_read_b32 v1, v16 offset:0
    s_waitcnt lgkmcnt(0)
    v_readfirstlane_b32 s48, v1
L_blk:
    s_add_u32 s56, s49, 7
    s_cmp_ge_i32 s48, s56
    s_cbranch_scc0 L_blk4
    s_cmp_lt_u32 s56, s50
    s_cbranch_scc0 L_blk4
    ds_read2_b64 v[96:99], v22 offset0:0 offset1:32
    ds_read_b64_tr_b16 v[64:65], v20 offset:0
    ds_read_b64_tr_b16 v[66:67], v20 offset:4096
    ds_read_b64_tr_b16 v[68:69], v21 offset:0
    ds_read_b64_tr_b16 v[70:71], v21 offset:4096
    ds_read2_b64 v[100:103], v22 offset0:64 offset1:96
    ds_read_b64_tr_b16 v[72:73], v20 offset:8192
    ds_read_b64_tr_b16 v[74:75], v20 offset:12288
    ds_read_b64_tr_b16 v[76:77], v21 offset:8192
    ds_read_b64_tr_b16 v[78:79], v21 offset:12288
    ds_read2_b64 v[104:107], v22 offset0:128 offset1:160
    ds_read_b64_tr_b16 v[80:81], v20 offset:16384
    ds_read_b64_tr_b16 v[82:83], v20 offset:20480
    ds_read_b64_tr_b16 v[84:85], v21 offset:16384
    ds_read_b64_tr_b16 v[86:87], v21 offset:20480
    s_add_u32 s49, s49, 8
    s_cmp_lt_u32 s49, s50
    s_waitcnt lgkmcnt(10)
    ds_read2_b64 v[108:111], v22 offset0:192 offset1:224
    ds_read_b64_tr_b16 v[88:89], v20 offset:24576
    ds_read_b64_tr_b16 v[90:91], v20 offset:28672
    ds_read_b64_tr_b16 v[92:93], v21 offset:24576
    ds_read_b64_tr_b16 v[94:95], v21 offset:28672
    v_mfma_f32_16x16x32_bf16 v[32:35], v[64:67], v[96:99], v[32:35]
    v_mfma_f32_16x16x32_bf16 v[36:39], v[68:71], v[96:99], v[36:39]
    v_add_u32 v22, 0x800, v22
    v_add_u32 v20, 0x8000, v20
    v_add_u32 v21, 0x8000, v21
    s_waitcnt lgkmcnt(10)
    v_mfma_f32_16x16x32_bf16 v[32:35], v[72:75], v[100:103], v[32:35]
    v_mfma_f32_16x16x32_bf16 v[36:39], v[76:79], v[100:103], v[36:39]
    s_waitcnt lgkmcnt(5)
    v_mfma_f32_16x16x32_bf16 v[32:35], v[80:83], v[104:107], v[32:35]
    v_mfma_f32_16x16x32_bf16 v[36:39], v[84:87], v[104:107], v[36:39]
    s_waitcnt lgkmcnt(0)
    v_mfma_f32_16x16x32_bf16 v[32:35], v[88:91], v[108:111], v[32:35]
    v_mfma_f32_16x16x32_bf16 v[36:39], v[92:95], v[108:111], v[36:39]
    s_cbranch_scc1 L_blk
    s_setpc_b64 s[52:53]
L_blk4:
    s_add_u32 s56, s49, 3
    s_cmp_ge_i32 s48, s56
    s_cbranch_scc0 L_blk1
    s_cmp_lt_u32 s56, s50
    s_cbranch_scc0 L_blk1
    ds_read2_b64 v[96:99], v22 offset0:0 offset1:32
    ds_read_b64_tr_b16 v[64:65], v20 offset:0
    ds_read_b64_tr_b16 v[66:67], v20 offset:4096
    ds_read_b64_tr_b16 v[68:69], v21 offset:0
    ds_read_b64_tr_b16 v[70:71], v21 offset:4096
    ds_read2_b64 v[100:103], v22 offset0:64 offset1:96
    ds_read_b64_tr_b16 v[72:73], v20 offset:8192
    ds_read_b64_tr_b16 v[74:75], v20 offset:12288
    ds_read_b64_tr_b16 v[76:77], v21 offset:8192
    ds_read_b64_tr_b16 v[78:79], v21 offset:12288
    v_add_u32 v22, 0x400, v22
    v_add_u32 v20, 0x4000, v20
    v_add_u32 v21, 0x4000, v21
    s_add_u32 s49, s49, 4
    s_cmp_lt_u32 s49, s50
    s_waitcnt lgkmcnt(5)
    v_mfma_f32_16x16x32_bf16 v[32:35], v[64:67], v[96:99], v[32:35]
    v_mfma_f32_16x16x32_bf16 v[36:39], v[68:71], v[96:99], v[36:39]
    s_waitcnt lgkmcnt(0)
    v_mfma_f32_16x16x32_bf16 v[32:35], v[72:75], v[100:103], v[32:35]
    v_mfma_f32_16x16x32_bf16 v[36:39], v[76:79], v[100:103], v[36:39]
    s_cbranch_scc1 L_blk
L_ret:
    s_setpc_b64 s[52:53]
L_blk1:
    ds_read_b32 v1, v16 offset:0
    ds_read2_b64 v[96:99], v22 offset0:0 offset1:32
    ds_read_b64_tr_b16 v[64:65], v20 offset:0
    ds_read_b64_tr_b16 v[66:67], v20 offset:4096
    ds_read_b64_tr_b16 v[68:69], v21 offset:0
    ds_read_b64_tr_b16 v[70:71], v21 offset:4096
    s_waitcnt lgkmcnt(5)
    v_readfirstlane_b32 s48, v1
    s_cmp_gt_i32 s48, s49
    s_cbranch_scc1 L_blk_go
    s_sub_u32 s46, s46, 1
    s_cbranch_scc1 L_end
    s_cmp_eq_u32 s48, s49
    s_waitcnt lgkmcnt(0)
    s_cbranch_scc1 L_blk1
    s_sleep 0
    s_branch L_blk1
L_blk_go:
    v_add_u32 v22, 0x200, v22
    v_add_u32 v20, 0x2000, v20
    v_add_u32 v21, 0x2000, v21
    s_add_u32 s49, s49, 2
    s_cmp_lt_u32 s49, s50
    s_waitcnt lgkmcnt(2)
    v_mfma_f32_16x16x32_bf16 v[32:35], v[64:67], v[96:99], v[32:35]
    s_waitcnt lgkmcnt(0)
    v_mfma_f32_16x16x32_bf16 v[36:39], v[68:71], v[96:99], v[36:39]
    s_cbranch_scc1 L_blk
L_last:
    s_setpc_b64 s[52:53]
.section .rodata,"a"
.p2align 6
.amdhsa_kernel gated_mix__sliding_block_cached__glu_gated_reglu__decode_kernel
  .amdhsa_next_free_vgpr 160
  .amdhsa_next_free_sgpr 100
  .amdhsa_accum_offset 160
  .amdhsa_group_segment_fixed_size 0
  .amdhsa_kernarg_size 104
  .amdhsa_user_sgpr_count 2
  .amdhsa_user_sgpr_kernarg_segment_ptr 1
  .amdhsa_system_sgpr_workgroup_id_x 1
.end_amdhsa_kernel
```
